```python
import torch

def _softmax(x, axis=-1):
    return torch.softmax(x, dim=axis)

def _gelu(x):
    return torch.nn.functional.gelu(x, approximate='tanh')

def _silu(x):
    return torch.nn.functional.silu(x)

def _sigmoid(x):
    return torch.sigmoid(x)

def _layernorm(x, axis=-1, eps=1e-05):
    m = x.mean(dim=axis, keepdim=True)
    v = x.var(dim=axis, keepdim=True, unbiased=False)
    return (x - m) / torch.sqrt(v + eps)

def _scatter_add(tgt, idx, src, axis=0):
    return tgt.clone().index_add_(axis, idx, src)

def _segment_sum(src, seg, n):
    out = torch.zeros((n,) + src.shape[1:], dtype=src.dtype)
    return out.index_add_(0, seg, src)

def _pad(x, pw):
    flat = tuple((v for pair in reversed(pw) for v in pair))
    return torch.nn.functional.pad(x, flat)
kernel_name = 'standalone__dit_adaln_block__diffusion'

def setup_inputs():

    _w = lambda a: (lambda t: t.to(torch.bfloat16) if t.is_floating_point() else t)(torch.as_tensor(a))
    B, N, D = (2, 256, 1152)
    return {'x': _w((lambda *s: torch.randn(*s, dtype=torch.bfloat16) * 0.05)(B, N, D)), 'c': _w((lambda *s: torch.randn(*s, dtype=torch.bfloat16) * 0.2)(B, D)), 'wqkv': _w((lambda *s: torch.randn(*s, dtype=torch.bfloat16) * 0.05)(D, 3 * D)), 'wo': _w((lambda *s: torch.randn(*s, dtype=torch.bfloat16) * 0.05)(D, D)), 'w_mod': _w((lambda *s: torch.randn(*s, dtype=torch.bfloat16) * 0.2)(D, 6 * D))}

def reference(x, c, wqkv, wo, w_mod):
    B, N, D = x.shape
    mod = (_silu(c) @ w_mod).reshape(B, 6, 1, D)
    shift_a, scale_a, gate_a, shift_m, scale_m, gate_m = [mod[:, i] for i in range(6)]
    h = _layernorm(x, axis=-1) * (1 + scale_a) + shift_a
    qkv = h @ wqkv
    q, k, v = (qkv[..., :D].clone(), qkv[..., D:2 * D].clone(), qkv[..., 2 * D:].clone())
    p = _softmax(torch.einsum('bqd,bkd->bqk', q, k) * D ** (-0.5), axis=-1)
    a = torch.einsum('bqk,bkd->bqd', p, v) @ wo
    return x + gate_a * a
```

```asm
; @launch grid=(256,1,1) block=(512,1,1) lds=163840
.amdgcn_target "amdgcn-amd-amdhsa--gfx950"
.text
.globl standalone__dit_adaln_block__diffusion_kernel
.p2align 8
.type standalone__dit_adaln_block__diffusion_kernel,@function
standalone__dit_adaln_block__diffusion_kernel:
    s_cmp_ge_u32 s2, 256
    s_cbranch_scc1 L_end
    s_load_dwordx16 s[16:31], s[0:1], 0
    v_lshrrev_b32 v1, 6, v0
    v_and_b32 v0, 63, v0
    s_and_b32 s5, s2, 7
    v_readfirstlane_b32 s3, v1
    s_lshr_b32 s6, s2, 3
    s_mov_b32 s7, 0x40000
    v_lshlrev_b32 v1, 4, v0
    v_lshrrev_b32 v7, 5, v0
    v_and_b32 v8, 31, v0
    s_mov_b32 s8, s2
    s_cmp_lg_u32 s3, 7
    s_cbranch_scc1 L_nocpf
    s_getpc_b64 s[48:49]
L_pc:
    s_sub_u32 s48, s48, L_pc-standalone__dit_adaln_block__diffusion_kernel
    s_subb_u32 s49, s49, 0
    s_lshl_b32 s50, s6, 10
    v_add_u32 v9, s50, v1
    v_min_u32 v9, L_codeend-standalone__dit_adaln_block__diffusion_kernel-16, v9
    global_load_dwordx4 v[240:243], v9, s[48:49]
L_nocpf:
    s_mul_i32 s48, s5, 27
    s_add_u32 s48, s48, s6
    s_sub_u32 s48, s48, 5
    s_lshr_b32 s49, s48, 2
    s_sub_u32 s50, s48, s49
    s_add_u32 s50, s50, 93
    s_and_b32 s51, s49, 1
    s_mul_i32 s51, s51, 27
    s_lshr_b32 s49, s49, 1
    s_add_u32 s49, s49, s51
    s_add_u32 s49, s49, 40
    s_and_b32 s48, s48, 3
    s_cselect_b32 s49, s50, s49
    s_cmp_ge_u32 s2, 40
    s_cselect_b32 s8, s49, s2
    s_cmp_ge_u32 s8, 64
    s_cbranch_scc1 L_s0_nst
    s_lshl_b32 s51, s8, 3
    s_add_u32 s51, s51, s3
    s_mul_i32 s51, s51, 2304
    v_mov_b32 v24, 0
    v_mov_b32 v25, 0
    v_mov_b32 v26, 0
    v_mov_b32 v27, 0
    s_and_b32 s61, s2, 1
    s_lshr_b32 s60, s2, 1
    s_lshl_b32 s61, s61, 3
    s_add_u32 s61, s61, s3
    v_lshrrev_b32 v6, 3, v0
    v_mul_u32_u24 v9, 2304, v6
    v_and_b32 v10, 7, v0
    v_xor_b32 v10, v10, v6
    v_lshl_add_u32 v9, v10, 4, v9
    s_mul_i32 s61, s61, 73728
    s_lshl_b32 s60, s60, 7
    s_add_u32 s61, s61, s60
    s_lshl_b32 m0, s3, 12
    s_waitcnt lgkmcnt(0)
    s_mov_b32 s40, s16
    s_and_b32 s41, s17, 0xffff
    s_mov_b32 s42, 0x120000
    s_mov_b32 s43, 0x20000
    buffer_load_dwordx4 v[16:19], v1, s[40:43], s51 offen
    buffer_load_dwordx4 v[20:23], v1, s[40:43], s51 offen offset:1024
    s_mov_b64 exec, 0xffff
    buffer_load_dwordx4 v[24:27], v1, s[40:43], s51 offen offset:2048
    s_mov_b64 exec, -1
    s_mov_b32 s4, 77824
    s_load_dword s4, s[30:31], s4
    s_cmp_ge_u32 s2, 36
    s_cbranch_scc1 L_s0_stats
    s_barrier
    buffer_load_dwordx4 v9, s[40:43], s61 offen lds
    s_add_u32 s61, s61, 18432
    s_add_u32 m0, m0, 1024
    s_nop 0
    buffer_load_dwordx4 v9, s[40:43], s61 offen lds
    s_add_u32 s61, s61, 18432
    s_add_u32 m0, m0, 1024
    s_nop 0
    buffer_load_dwordx4 v9, s[40:43], s61 offen lds
    s_add_u32 s61, s61, 18432
    s_add_u32 m0, m0, 1024
    s_nop 0
    buffer_load_dwordx4 v9, s[40:43], s61 offen lds
    s_branch L_s0_stats
L_s0_nst:
    s_cmp_lt_u32 s8, 94
    s_cbranch_scc1 L_s0_none
    s_sub_u32 s48, s8, 94
    s_mul_i32 s50, s48, 57
    s_lshr_b32 s50, s50, 9
    s_mul_i32 s49, s50, 9
    s_sub_u32 s49, s48, s49
    s_lshl_b32 s52, s50, 3
    s_add_u32 s52, s52, s3
    s_lshl_b32 s52, s52, 3
    v_and_b32 v9, 15, v0
    v_lshlrev_b32 v9, 4, v9
    v_bfe_u32 v10, v0, 4, 1
    v_mul_u32_u24 v10, 2304, v10
    v_mul_u32_u24 v11, 55296, v7
    v_add3_u32 v9, v9, v10, v11
    v_lshlrev_b32 v10, 3, v7
    s_lshl_b32 s53, s52, 1
    s_mul_i32 s51, s52, 13824
    s_lshl_b32 s52, s49, 8
    s_add_u32 s51, s51, s52
    s_waitcnt lgkmcnt(0)
    s_mov_b32 s32, s24
    s_and_b32 s33, s25, 0xffff
    s_mov_b32 s34, 0xf30000
    s_mov_b32 s35, 0x20000
    s_mov_b32 s40, s18
    s_and_b32 s41, s19, 0xffff
    s_mov_b32 s42, 0x1200
    s_mov_b32 s43, 0x20000
    buffer_load_dwordx2 v[32:33], v10, s[40:43], s53 offen
    buffer_load_dwordx2 v[34:35], v10, s[40:43], s53 offen offset:2304
    buffer_load_dwordx4 v[16:19], v9, s[32:35], s51 offen
    s_add_u32 s51, s51, 13824
    buffer_load_dwordx4 v[20:23], v9, s[32:35], s51 offen
    s_add_u32 s51, s51, 13824
    buffer_load_dwordx4 v[24:27], v9, s[32:35], s51 offen
    s_add_u32 s51, s51, 13824
    buffer_load_dwordx4 v[28:31], v9, s[32:35], s51 offen
    s_mov_b32 s4, 77824
    s_load_dword s4, s[30:31], s4
    s_mov_b32 s44, s30
    s_and_b32 s45, s31, 0xffff
    s_mov_b32 s46, 0x10000000
    s_mov_b32 s47, 0x20000
    v_lshrrev_b32 v6, 3, v0
    v_and_b32 v2, 0x33, v0
    v_and_b32 v9, 4, v0
    v_lshl_or_b32 v2, v9, 1, v2
    v_and_b32 v9, 8, v0
    v_lshrrev_b32 v9, 1, v9
    v_or_b32 v2, v2, v9
    v_lshlrev_b32 v2, 4, v2
    v_lshrrev_b32 v9, 2, v0
    v_and_b32 v9, 4, v9
    v_and_b32 v5, 7, v0
    v_xor_b32 v5, v5, v9
    v_lshlrev_b32 v3, 10, v7
    v_and_b32 v9, 12, v0
    v_lshl_or_b32 v3, v9, 5, v3
    v_and_b32 v9, 8, v0
    v_lshl_or_b32 v3, v9, 3, v3
    v_and_b32 v9, 16, v0
    v_lshl_or_b32 v3, v9, 1, v3
    v_and_b32 v9, 1, v0
    v_lshl_or_b32 v3, v9, 4, v3
    v_and_b32 v9, 2, v0
    v_lshl_or_b32 v3, v9, 2, v3
    v_xor_b32 v4, 64, v3
    s_mov_b32 s36, s20
    s_and_b32 s37, s21, 0xffff
    s_mov_b32 s38, 0x798000
    s_mov_b32 s39, 0x20000
    s_mul_i32 s11, s5, 27
    s_add_u32 s11, s11, s6
    s_sub_u32 s11, s11, 5
    s_and_b32 s12, s11, 3
    s_lshr_b32 s11, s11, 2
    s_mul_i32 s13, s12, 28
    s_add_u32 s62, s13, 36
    s_cmp_lg_u32 s12, 0
    s_cselect_b32 s13, s62, s13
    s_add_u32 s13, s13, s3
    v_lshlrev_b32 v15, 4, v5
    v_mul_u32_u24 v9, 6912, v6
    s_lshl_b32 s62, s11, 7
    v_add3_u32 v15, v15, v9, s62
    s_barrier
    s_lshl_b32 m0, s13, 10
    s_mul_i32 s62, s13, 55296
    buffer_load_dwordx4 v15, s[36:39], s62 offen  lds
    s_add_u32 s13, s13, 8
    s_sub_u32 s62, s13, 144
    s_cmp_ge_u32 s13, 144
    s_cselect_b32 s13, s62, s13
    s_lshl_b32 m0, s13, 10
    s_mul_i32 s62, s13, 55296
    buffer_load_dwordx4 v15, s[36:39], s62 offen  lds
    s_add_u32 s13, s13, 8
    s_sub_u32 s62, s13, 144
    s_cmp_ge_u32 s13, 144
    s_cselect_b32 s13, s62, s13
    s_lshl_b32 m0, s13, 10
    s_mul_i32 s62, s13, 55296
    buffer_load_dwordx4 v15, s[36:39], s62 offen  lds
    s_add_u32 s13, s13, 8
    s_sub_u32 s62, s13, 144
    s_cmp_ge_u32 s13, 144
    s_cselect_b32 s13, s62, s13
    s_waitcnt vmcnt(7)
    v_lshlrev_b32 v36, 16, v32
    v_and_b32 v37, 0xffff0000, v32
    v_lshlrev_b32 v38, 16, v33
    v_and_b32 v39, 0xffff0000, v33
    v_lshlrev_b32 v40, 16, v34
    v_and_b32 v41, 0xffff0000, v34
    v_lshlrev_b32 v42, 16, v35
    v_and_b32 v43, 0xffff0000, v35
    v_mul_f32 v44, 0xbfb8aa3b, v36
    v_mul_f32 v45, 0xbfb8aa3b, v37
    v_mul_f32 v46, 0xbfb8aa3b, v38
    v_mul_f32 v47, 0xbfb8aa3b, v39
    v_mul_f32 v48, 0xbfb8aa3b, v40
    v_mul_f32 v49, 0xbfb8aa3b, v41
    v_mul_f32 v50, 0xbfb8aa3b, v42
    v_mul_f32 v51, 0xbfb8aa3b, v43
    v_exp_f32 v44, v44
    v_exp_f32 v45, v45
    v_exp_f32 v46, v46
    v_exp_f32 v47, v47
    v_exp_f32 v48, v48
    v_exp_f32 v49, v49
    v_exp_f32 v50, v50
    v_exp_f32 v51, v51
    v_add_f32 v44, 1.0, v44
    v_add_f32 v45, 1.0, v45
    v_add_f32 v46, 1.0, v46
    v_add_f32 v47, 1.0, v47
    v_add_f32 v48, 1.0, v48
    v_add_f32 v49, 1.0, v49
    v_add_f32 v50, 1.0, v50
    v_add_f32 v51, 1.0, v51
    v_rcp_f32 v44, v44
    v_rcp_f32 v45, v45
    v_rcp_f32 v46, v46
    v_rcp_f32 v47, v47
    v_rcp_f32 v48, v48
    v_rcp_f32 v49, v49
    v_rcp_f32 v50, v50
    v_rcp_f32 v51, v51
    v_mul_f32 v36, v36, v44
    v_mul_f32 v37, v37, v45
    v_mul_f32 v38, v38, v46
    v_mul_f32 v39, v39, v47
    v_mul_f32 v40, v40, v48
    v_mul_f32 v41, v41, v49
    v_mul_f32 v42, v42, v50
    v_mul_f32 v43, v43, v51
    v_cvt_pk_bf16_f32 v32, v36, v37
    v_cvt_pk_bf16_f32 v33, v38, v39
    v_cvt_pk_bf16_f32 v34, v40, v41
    v_cvt_pk_bf16_f32 v35, v42, v43
    v_lshlrev_b32 v36, 16, v32
    v_and_b32 v37, 0xffff0000, v32
    v_lshlrev_b32 v38, 16, v33
    v_and_b32 v39, 0xffff0000, v33
    v_lshlrev_b32 v40, 16, v34
    v_and_b32 v41, 0xffff0000, v34
    v_lshlrev_b32 v42, 16, v35
    v_and_b32 v43, 0xffff0000, v35
    s_lshl_b32 s51, s3, 11
    s_add_u32 s51, s51, 147456
    v_lshlrev_b32 v11, 5, v0
    v_add_u32 v11, s51, v11
    s_lshr_b32 s51, s3, 1
    s_lshl_b32 s51, s51, 10
    s_and_b32 s52, s3, 1
    s_lshl_b32 s48, s52, 8
    s_add_u32 s51, s51, s48
    s_add_u32 s51, s51, 147456
    v_lshlrev_b32 v12, 3, v8
    v_lshl_add_u32 v12, v7, 9, v12
    v_add_u32 v12, s51, v12
    s_lshl_b32 s48, s49, 1
    s_add_u32 s48, s48, s52
    s_lshl_b32 s48, s48, 1
    s_lshr_b32 s51, s3, 1
    s_add_u32 s48, s48, s51
    s_mul_i32 s48, s48, 18
    s_add_u32 s48, s48, s50
    s_lshl_b32 s48, s48, 10
    s_add_u32 s48, s48, 4849664
    v_and_b32 v9, 28, v0
    v_lshlrev_b32 v9, 5, v9
    v_lshl_add_u32 v9, v7, 6, v9
    v_and_b32 v10, 3, v0
    v_lshl_add_u32 v9, v10, 4, v9
    s_waitcnt lgkmcnt(0)
    s_mul_i32 s4, s4, 1664525
    s_add_u32 s4, s4, 1013904223
    v_mov_b32 v13, s4
    s_waitcnt vmcnt(6)
    v_lshlrev_b32 v44, 16, v16
    v_and_b32 v45, 0xffff0000, v16
    v_lshlrev_b32 v46, 16, v17
    v_and_b32 v47, 0xffff0000, v17
    v_lshlrev_b32 v48, 16, v18
    v_and_b32 v49, 0xffff0000, v18
    v_lshlrev_b32 v50, 16, v19
    v_and_b32 v51, 0xffff0000, v19
    v_mul_f32 v52, v44, v36
    v_mul_f32 v53, v45, v36
    v_mul_f32 v54, v46, v36
    v_mul_f32 v55, v47, v36
    v_mul_f32 v56, v48, v36
    v_mul_f32 v57, v49, v36
    v_mul_f32 v58, v50, v36
    v_mul_f32 v59, v51, v36
    v_mul_f32 v60, v44, v40
    v_mul_f32 v61, v45, v40
    v_mul_f32 v62, v46, v40
    v_mul_f32 v63, v47, v40
    v_mul_f32 v64, v48, v40
    v_mul_f32 v65, v49, v40
    v_mul_f32 v66, v50, v40
    v_mul_f32 v67, v51, v40
    s_waitcnt vmcnt(5)
    v_lshlrev_b32 v44, 16, v20
    v_and_b32 v45, 0xffff0000, v20
    v_lshlrev_b32 v46, 16, v21
    v_and_b32 v47, 0xffff0000, v21
    v_lshlrev_b32 v48, 16, v22
    v_and_b32 v49, 0xffff0000, v22
    v_lshlrev_b32 v50, 16, v23
    v_and_b32 v51, 0xffff0000, v23
    v_fmac_f32 v52, v44, v37
    v_fmac_f32 v53, v45, v37
    v_fmac_f32 v54, v46, v37
    v_fmac_f32 v55, v47, v37
    v_fmac_f32 v56, v48, v37
    v_fmac_f32 v57, v49, v37
    v_fmac_f32 v58, v50, v37
    v_fmac_f32 v59, v51, v37
    v_fmac_f32 v60, v44, v41
    v_fmac_f32 v61, v45, v41
    v_fmac_f32 v62, v46, v41
    v_fmac_f32 v63, v47, v41
    v_fmac_f32 v64, v48, v41
    v_fmac_f32 v65, v49, v41
    v_fmac_f32 v66, v50, v41
    v_fmac_f32 v67, v51, v41
    s_waitcnt vmcnt(4)
    v_lshlrev_b32 v44, 16, v24
    v_and_b32 v45, 0xffff0000, v24
    v_lshlrev_b32 v46, 16, v25
    v_and_b32 v47, 0xffff0000, v25
    v_lshlrev_b32 v48, 16, v26
    v_and_b32 v49, 0xffff0000, v26
    v_lshlrev_b32 v50, 16, v27
    v_and_b32 v51, 0xffff0000, v27
    v_fmac_f32 v52, v44, v38
    v_fmac_f32 v53, v45, v38
    v_fmac_f32 v54, v46, v38
    v_fmac_f32 v55, v47, v38
    v_fmac_f32 v56, v48, v38
    v_fmac_f32 v57, v49, v38
    v_fmac_f32 v58, v50, v38
    v_fmac_f32 v59, v51, v38
    v_fmac_f32 v60, v44, v42
    v_fmac_f32 v61, v45, v42
    v_fmac_f32 v62, v46, v42
    v_fmac_f32 v63, v47, v42
    v_fmac_f32 v64, v48, v42
    v_fmac_f32 v65, v49, v42
    v_fmac_f32 v66, v50, v42
    v_fmac_f32 v67, v51, v42
    s_waitcnt vmcnt(3)
    v_lshlrev_b32 v44, 16, v28
    v_and_b32 v45, 0xffff0000, v28
    v_lshlrev_b32 v46, 16, v29
    v_and_b32 v47, 0xffff0000, v29
    v_lshlrev_b32 v48, 16, v30
    v_and_b32 v49, 0xffff0000, v30
    v_lshlrev_b32 v50, 16, v31
    v_and_b32 v51, 0xffff0000, v31
    v_fmac_f32 v52, v44, v39
    v_fmac_f32 v53, v45, v39
    v_fmac_f32 v54, v46, v39
    v_fmac_f32 v55, v47, v39
    v_fmac_f32 v56, v48, v39
    v_fmac_f32 v57, v49, v39
    v_fmac_f32 v58, v50, v39
    v_fmac_f32 v59, v51, v39
    v_fmac_f32 v60, v44, v43
    v_fmac_f32 v61, v45, v43
    v_fmac_f32 v62, v46, v43
    v_fmac_f32 v63, v47, v43
    v_fmac_f32 v64, v48, v43
    v_fmac_f32 v65, v49, v43
    v_fmac_f32 v66, v50, v43
    v_fmac_f32 v67, v51, v43
    s_nop 1
    v_permlane32_swap_b32 v52, v60
    v_permlane32_swap_b32 v53, v61
    v_permlane32_swap_b32 v54, v62
    v_permlane32_swap_b32 v55, v63
    v_permlane32_swap_b32 v56, v64
    v_permlane32_swap_b32 v57, v65
    v_permlane32_swap_b32 v58, v66
    v_permlane32_swap_b32 v59, v67
    v_add_f32 v52, v52, v60
    v_add_f32 v53, v53, v61
    v_add_f32 v54, v54, v62
    v_add_f32 v55, v55, v63
    v_add_f32 v56, v56, v64
    v_add_f32 v57, v57, v65
    v_add_f32 v58, v58, v66
    v_add_f32 v59, v59, v67
    ds_write_b128 v11, v[52:55]
    ds_write_b128 v11, v[56:59] offset:16
    s_waitcnt lgkmcnt(0)
    s_barrier
    s_cmp_ge_u32 s3, 4
    s_cbranch_scc1 L_pubsk_1
    ds_read_b64 v[16:17], v12 offset:0
    ds_read_b64 v[18:19], v12 offset:2048
    ds_read_b64 v[20:21], v12 offset:4096
    ds_read_b64 v[22:23], v12 offset:6144
    ds_read_b64 v[24:25], v12 offset:8192
    ds_read_b64 v[26:27], v12 offset:10240
    ds_read_b64 v[28:29], v12 offset:12288
    ds_read_b64 v[30:31], v12 offset:14336
    v_mov_b32 v53, v13
    v_mov_b32 v55, v13
    s_waitcnt lgkmcnt(4)
    v_add_f32 v16, v16, v18
    v_add_f32 v17, v17, v19
    v_add_f32 v20, v20, v22
    v_add_f32 v21, v21, v23
    s_waitcnt lgkmcnt(0)
    v_add_f32 v24, v24, v26
    v_add_f32 v25, v25, v27
    v_add_f32 v28, v28, v30
    v_add_f32 v29, v29, v31
    v_add_f32 v16, v16, v20
    v_add_f32 v17, v17, v21
    v_add_f32 v24, v24, v28
    v_add_f32 v25, v25, v29
    v_add_f32 v52, v16, v24
    v_add_f32 v54, v17, v25
    buffer_store_dwordx4 v[52:55], v9, s[44:47], s48 offen sc1
L_pubsk_1:
    s_barrier
    s_lshl_b32 m0, s13, 10
    s_mul_i32 s62, s13, 55296
    buffer_load_dwordx4 v15, s[36:39], s62 offen  lds
    s_add_u32 s13, s13, 8
    s_sub_u32 s62, s13, 144
    s_cmp_ge_u32 s13, 144
    s_cselect_b32 s13, s62, s13
    s_lshl_b32 m0, s13, 10
    s_mul_i32 s62, s13, 55296
    buffer_load_dwordx4 v15, s[36:39], s62 offen  lds
    s_add_u32 s13, s13, 8
    s_sub_u32 s62, s13, 144
    s_cmp_ge_u32 s13, 144
    s_cselect_b32 s13, s62, s13
    s_lshl_b32 m0, s13, 10
    s_mul_i32 s62, s13, 55296
    buffer_load_dwordx4 v15, s[36:39], s62 offen  lds
    s_add_u32 s13, s13, 8
    s_sub_u32 s62, s13, 144
    s_cmp_ge_u32 s13, 144
    s_cselect_b32 s13, s62, s13
    s_lshl_b32 m0, s13, 10
    s_mul_i32 s62, s13, 55296
    buffer_load_dwordx4 v15, s[36:39], s62 offen  lds
    s_add_u32 s13, s13, 8
    s_sub_u32 s62, s13, 144
    s_cmp_ge_u32 s13, 144
    s_cselect_b32 s13, s62, s13
    s_lshl_b32 m0, s13, 10
    s_mul_i32 s62, s13, 55296
    buffer_load_dwordx4 v15, s[36:39], s62 offen  lds
    s_add_u32 s13, s13, 8
    s_sub_u32 s62, s13, 144
    s_cmp_ge_u32 s13, 144
    s_cselect_b32 s13, s62, s13
    s_lshl_b32 m0, s13, 10
    s_mul_i32 s62, s13, 55296
    buffer_load_dwordx4 v15, s[36:39], s62 offen  lds
    s_add_u32 s13, s13, 8
    s_sub_u32 s62, s13, 144
    s_cmp_ge_u32 s13, 144
    s_cselect_b32 s13, s62, s13
    s_lshl_b32 m0, s13, 10
    s_mul_i32 s62, s13, 55296
    buffer_load_dwordx4 v15, s[36:39], s62 offen  lds
    s_add_u32 s13, s13, 8
    s_sub_u32 s62, s13, 144
    s_cmp_ge_u32 s13, 144
    s_cselect_b32 s13, s62, s13
    s_lshl_b32 m0, s13, 10
    s_mul_i32 s62, s13, 55296
    buffer_load_dwordx4 v15, s[36:39], s62 offen  lds
    s_add_u32 s13, s13, 8
    s_sub_u32 s62, s13, 144
    s_cmp_ge_u32 s13, 144
    s_cselect_b32 s13, s62, s13
    s_lshl_b32 m0, s13, 10
    s_mul_i32 s62, s13, 55296
    buffer_load_dwordx4 v15, s[36:39], s62 offen  lds
    s_add_u32 s13, s13, 8
    s_sub_u32 s62, s13, 144
    s_cmp_ge_u32 s13, 144
    s_cselect_b32 s13, s62, s13
    s_lshl_b32 m0, s13, 10
    s_mul_i32 s62, s13, 55296
    buffer_load_dwordx4 v15, s[36:39], s62 offen  lds
    s_add_u32 s13, s13, 8
    s_sub_u32 s62, s13, 144
    s_cmp_ge_u32 s13, 144
    s_cselect_b32 s13, s62, s13
    s_lshl_b32 m0, s13, 10
    s_mul_i32 s62, s13, 55296
    buffer_load_dwordx4 v15, s[36:39], s62 offen  lds
    s_add_u32 s13, s13, 8
    s_sub_u32 s62, s13, 144
    s_cmp_ge_u32 s13, 144
    s_cselect_b32 s13, s62, s13
    s_lshl_b32 m0, s13, 10
    s_mul_i32 s62, s13, 55296
    buffer_load_dwordx4 v15, s[36:39], s62 offen  lds
    s_add_u32 s13, s13, 8
    s_sub_u32 s62, s13, 144
    s_cmp_ge_u32 s13, 144
    s_cselect_b32 s13, s62, s13
    s_lshl_b32 m0, s13, 10
    s_mul_i32 s62, s13, 55296
    buffer_load_dwordx4 v15, s[36:39], s62 offen  lds
    s_add_u32 s13, s13, 8
    s_sub_u32 s62, s13, 144
    s_cmp_ge_u32 s13, 144
    s_cselect_b32 s13, s62, s13
    s_lshl_b32 m0, s13, 10
    s_mul_i32 s62, s13, 55296
    buffer_load_dwordx4 v15, s[36:39], s62 offen  lds
    s_add_u32 s13, s13, 8
    s_sub_u32 s62, s13, 144
    s_cmp_ge_u32 s13, 144
    s_cselect_b32 s13, s62, s13
    s_lshl_b32 m0, s13, 10
    s_mul_i32 s62, s13, 55296
    buffer_load_dwordx4 v15, s[36:39], s62 offen  lds
    s_add_u32 s13, s13, 8
    s_sub_u32 s62, s13, 144
    s_cmp_ge_u32 s13, 144
    s_cselect_b32 s13, s62, s13
    s_branch L_b
L_s0_stats:
    s_mov_b32 s44, s30
    s_and_b32 s45, s31, 0xffff
    s_mov_b32 s46, 0x10000000
    s_mov_b32 s47, 0x20000
    v_lshrrev_b32 v6, 3, v0
    v_and_b32 v2, 0x33, v0
    v_and_b32 v9, 4, v0
    v_lshl_or_b32 v2, v9, 1, v2
    v_and_b32 v9, 8, v0
    v_lshrrev_b32 v9, 1, v9
    v_or_b32 v2, v2, v9
    v_lshlrev_b32 v2, 4, v2
    v_lshrrev_b32 v9, 2, v0
    v_and_b32 v9, 4, v9
    v_and_b32 v5, 7, v0
    v_xor_b32 v5, v5, v9
    v_lshlrev_b32 v3, 10, v7
    v_and_b32 v9, 12, v0
    v_lshl_or_b32 v3, v9, 5, v3
    v_and_b32 v9, 8, v0
    v_lshl_or_b32 v3, v9, 3, v3
    v_and_b32 v9, 16, v0
    v_lshl_or_b32 v3, v9, 1, v3
    v_and_b32 v9, 1, v0
    v_lshl_or_b32 v3, v9, 4, v3
    v_and_b32 v9, 2, v0
    v_lshl_or_b32 v3, v9, 2, v3
    v_xor_b32 v4, 64, v3
    s_waitcnt lgkmcnt(0)
    s_mul_i32 s4, s4, 1664525
    s_add_u32 s4, s4, 1013904223
    v_mov_b32 v13, s4
    s_cmp_ge_u32 s2, 36
    s_cbranch_scc1 L_nox_2
    s_waitcnt vmcnt(4)
    s_branch L_jx_3
L_nox_2:
    s_waitcnt vmcnt(0)
L_jx_3:
    s_mov_b32 s60, 0x3f803f80
    v_dot2_f32_bf16 v32, v16, s60, 0
    v_dot2_f32_bf16 v34, v16, v16, 0
    v_dot2_f32_bf16 v33, v17, s60, 0
    v_dot2_f32_bf16 v35, v17, v17, 0
    v_dot2_f32_bf16 v32, v18, s60, v32
    v_dot2_f32_bf16 v34, v18, v18, v34
    v_dot2_f32_bf16 v33, v19, s60, v33
    v_dot2_f32_bf16 v35, v19, v19, v35
    v_dot2_f32_bf16 v32, v20, s60, v32
    v_dot2_f32_bf16 v34, v20, v20, v34
    v_dot2_f32_bf16 v33, v21, s60, v33
    v_dot2_f32_bf16 v35, v21, v21, v35
    v_dot2_f32_bf16 v32, v22, s60, v32
    v_dot2_f32_bf16 v34, v22, v22, v34
    v_dot2_f32_bf16 v33, v23, s60, v33
    v_dot2_f32_bf16 v35, v23, v23, v35
    v_dot2_f32_bf16 v32, v24, s60, v32
    v_dot2_f32_bf16 v34, v24, v24, v34
    v_dot2_f32_bf16 v33, v25, s60, v33
    v_dot2_f32_bf16 v35, v25, v25, v35
    v_dot2_f32_bf16 v32, v26, s60, v32
    v_dot2_f32_bf16 v34, v26, v26, v34
    v_dot2_f32_bf16 v33, v27, s60, v33
    v_dot2_f32_bf16 v35, v27, v27, v35
    s_nop 2
    v_add_f32 v32, v32, v33
    v_add_f32 v34, v34, v35
    s_nop 0
    v_add_f32_dpp v32, v32, v32 quad_perm:[1,0,3,2] row_mask:0xf bank_mask:0xf
    v_add_f32_dpp v34, v34, v34 quad_perm:[1,0,3,2] row_mask:0xf bank_mask:0xf
    s_nop 0
    v_add_f32_dpp v32, v32, v32 quad_perm:[2,3,0,1] row_mask:0xf bank_mask:0xf
    v_add_f32_dpp v34, v34, v34 quad_perm:[2,3,0,1] row_mask:0xf bank_mask:0xf
    s_nop 0
    v_add_f32_dpp v32, v32, v32 row_half_mirror row_mask:0xf bank_mask:0xf
    v_add_f32_dpp v34, v34, v34 row_half_mirror row_mask:0xf bank_mask:0xf
    s_nop 0
    v_add_f32_dpp v32, v32, v32 row_mirror row_mask:0xf bank_mask:0xf
    v_add_f32_dpp v34, v34, v34 row_mirror row_mask:0xf bank_mask:0xf
    s_nop 0
    v_add_f32_dpp v32, v32, v32 row_bcast:15 row_mask:0xa bank_mask:0xf
    v_add_f32_dpp v34, v34, v34 row_bcast:15 row_mask:0xa bank_mask:0xf
    s_nop 0
    v_add_f32_dpp v32, v32, v32 row_bcast:31 row_mask:0xc bank_mask:0xf
    v_add_f32_dpp v34, v34, v34 row_bcast:31 row_mask:0xc bank_mask:0xf
    v_mul_f32 v36, 0x3a638e39, v32
    v_mul_f32 v38, 0x3a638e39, v34
    v_fma_f32 v38, -v36, v36, v38
    v_max_f32 v38, 0, v38
    v_cvt_pk_bf16_f32 v38, v38, v38
    v_lshlrev_b32 v38, 16, v38
    v_add_f32 v38, 0x3727c5ac, v38
    v_cvt_pk_bf16_f32 v38, v38, v38
    v_lshlrev_b32 v38, 16, v38
    v_sqrt_f32 v38, v38
    v_cvt_pk_bf16_f32 v36, v36, v36
    v_lshlrev_b32 v36, 16, v36
    v_cvt_pk_bf16_f32 v38, v38, v38
    v_lshlrev_b32 v38, 16, v38
    v_rcp_f32 v38, v38
    v_mov_b32 v37, v13
    v_mov_b32 v39, v13
    s_lshl_b32 s60, s3, 4
    s_add_u32 s60, s60, 160272
    v_mov_b32 v9, s60
    s_mov_b32 exec_lo, 0
    s_brev_b32 exec_hi, 1
    ds_write_b128 v9, v[36:39]
    s_mov_b64 exec, -1
    s_lshl_b32 s60, s8, 7
    s_add_u32 s60, s60, 0
    v_add_u32 v9, 160272, v1
    s_waitcnt lgkmcnt(0)
    s_barrier
    s_cmp_lg_u32 s3, 0
    s_cbranch_scc1 L_stsk_4
    s_mov_b64 exec, 0xff
    ds_read_b128 v[36:39], v9
    s_waitcnt lgkmcnt(0)
    buffer_store_dwordx4 v[36:39], v1, s[44:47], s60 offen sc1
    s_mov_b64 exec, -1
L_stsk_4:
    s_cmp_lt_u32 s6, 5
    s_cbranch_scc1 L_owner
    s_barrier
    s_branch L_s0_w
L_s0_none:
    s_waitcnt lgkmcnt(0)
    s_mov_b32 s4, 77824
    s_load_dword s4, s[30:31], s4
    s_mov_b32 s44, s30
    s_and_b32 s45, s31, 0xffff
    s_mov_b32 s46, 0x10000000
    s_mov_b32 s47, 0x20000
    v_lshrrev_b32 v6, 3, v0
    v_and_b32 v2, 0x33, v0
    v_and_b32 v9, 4, v0
    v_lshl_or_b32 v2, v9, 1, v2
    v_and_b32 v9, 8, v0
    v_lshrrev_b32 v9, 1, v9
    v_or_b32 v2, v2, v9
    v_lshlrev_b32 v2, 4, v2
    v_lshrrev_b32 v9, 2, v0
    v_and_b32 v9, 4, v9
    v_and_b32 v5, 7, v0
    v_xor_b32 v5, v5, v9
    v_lshlrev_b32 v3, 10, v7
    v_and_b32 v9, 12, v0
    v_lshl_or_b32 v3, v9, 5, v3
    v_and_b32 v9, 8, v0
    v_lshl_or_b32 v3, v9, 3, v3
    v_and_b32 v9, 16, v0
    v_lshl_or_b32 v3, v9, 1, v3
    v_and_b32 v9, 1, v0
    v_lshl_or_b32 v3, v9, 4, v3
    v_and_b32 v9, 2, v0
    v_lshl_or_b32 v3, v9, 2, v3
    v_xor_b32 v4, 64, v3
    s_waitcnt lgkmcnt(0)
    s_mul_i32 s4, s4, 1664525
    s_add_u32 s4, s4, 1013904223
    v_mov_b32 v13, s4
L_s0_w:
    s_mov_b32 s36, s20
    s_and_b32 s37, s21, 0xffff
    s_mov_b32 s38, 0x798000
    s_mov_b32 s39, 0x20000
    s_mul_i32 s11, s5, 27
    s_add_u32 s11, s11, s6
    s_sub_u32 s11, s11, 5
    s_and_b32 s12, s11, 3
    s_lshr_b32 s11, s11, 2
    s_mul_i32 s13, s12, 28
    s_add_u32 s62, s13, 36
    s_cmp_lg_u32 s12, 0
    s_cselect_b32 s13, s62, s13
    s_add_u32 s13, s13, s3
    v_lshlrev_b32 v15, 4, v5
    v_mul_u32_u24 v9, 6912, v6
    s_lshl_b32 s62, s11, 7
    v_add3_u32 v15, v15, v9, s62
    s_lshl_b32 m0, s13, 10
    s_mul_i32 s62, s13, 55296
    buffer_load_dwordx4 v15, s[36:39], s62 offen  lds
    s_add_u32 s13, s13, 8
    s_sub_u32 s62, s13, 144
    s_cmp_ge_u32 s13, 144
    s_cselect_b32 s13, s62, s13
    s_lshl_b32 m0, s13, 10
    s_mul_i32 s62, s13, 55296
    buffer_load_dwordx4 v15, s[36:39], s62 offen  lds
    s_add_u32 s13, s13, 8
    s_sub_u32 s62, s13, 144
    s_cmp_ge_u32 s13, 144
    s_cselect_b32 s13, s62, s13
    s_lshl_b32 m0, s13, 10
    s_mul_i32 s62, s13, 55296
    buffer_load_dwordx4 v15, s[36:39], s62 offen  lds
    s_add_u32 s13, s13, 8
    s_sub_u32 s62, s13, 144
    s_cmp_ge_u32 s13, 144
    s_cselect_b32 s13, s62, s13
    s_lshl_b32 m0, s13, 10
    s_mul_i32 s62, s13, 55296
    buffer_load_dwordx4 v15, s[36:39], s62 offen  lds
    s_add_u32 s13, s13, 8
    s_sub_u32 s62, s13, 144
    s_cmp_ge_u32 s13, 144
    s_cselect_b32 s13, s62, s13
    s_lshl_b32 m0, s13, 10
    s_mul_i32 s62, s13, 55296
    buffer_load_dwordx4 v15, s[36:39], s62 offen  lds
    s_add_u32 s13, s13, 8
    s_sub_u32 s62, s13, 144
    s_cmp_ge_u32 s13, 144
    s_cselect_b32 s13, s62, s13
    s_lshl_b32 m0, s13, 10
    s_mul_i32 s62, s13, 55296
    buffer_load_dwordx4 v15, s[36:39], s62 offen  lds
    s_add_u32 s13, s13, 8
    s_sub_u32 s62, s13, 144
    s_cmp_ge_u32 s13, 144
    s_cselect_b32 s13, s62, s13
    s_lshl_b32 m0, s13, 10
    s_mul_i32 s62, s13, 55296
    buffer_load_dwordx4 v15, s[36:39], s62 offen  lds
    s_add_u32 s13, s13, 8
    s_sub_u32 s62, s13, 144
    s_cmp_ge_u32 s13, 144
    s_cselect_b32 s13, s62, s13
    s_lshl_b32 m0, s13, 10
    s_mul_i32 s62, s13, 55296
    buffer_load_dwordx4 v15, s[36:39], s62 offen  lds
    s_add_u32 s13, s13, 8
    s_sub_u32 s62, s13, 144
    s_cmp_ge_u32 s13, 144
    s_cselect_b32 s13, s62, s13
    s_lshl_b32 m0, s13, 10
    s_mul_i32 s62, s13, 55296
    buffer_load_dwordx4 v15, s[36:39], s62 offen  lds
    s_add_u32 s13, s13, 8
    s_sub_u32 s62, s13, 144
    s_cmp_ge_u32 s13, 144
    s_cselect_b32 s13, s62, s13
    s_lshl_b32 m0, s13, 10
    s_mul_i32 s62, s13, 55296
    buffer_load_dwordx4 v15, s[36:39], s62 offen  lds
    s_add_u32 s13, s13, 8
    s_sub_u32 s62, s13, 144
    s_cmp_ge_u32 s13, 144
    s_cselect_b32 s13, s62, s13
    s_lshl_b32 m0, s13, 10
    s_mul_i32 s62, s13, 55296
    buffer_load_dwordx4 v15, s[36:39], s62 offen  lds
    s_add_u32 s13, s13, 8
    s_sub_u32 s62, s13, 144
    s_cmp_ge_u32 s13, 144
    s_cselect_b32 s13, s62, s13
    s_lshl_b32 m0, s13, 10
    s_mul_i32 s62, s13, 55296
    buffer_load_dwordx4 v15, s[36:39], s62 offen  lds
    s_add_u32 s13, s13, 8
    s_sub_u32 s62, s13, 144
    s_cmp_ge_u32 s13, 144
    s_cselect_b32 s13, s62, s13
    s_lshl_b32 m0, s13, 10
    s_mul_i32 s62, s13, 55296
    buffer_load_dwordx4 v15, s[36:39], s62 offen  lds
    s_add_u32 s13, s13, 8
    s_sub_u32 s62, s13, 144
    s_cmp_ge_u32 s13, 144
    s_cselect_b32 s13, s62, s13
    s_lshl_b32 m0, s13, 10
    s_mul_i32 s62, s13, 55296
    buffer_load_dwordx4 v15, s[36:39], s62 offen  lds
    s_add_u32 s13, s13, 8
    s_sub_u32 s62, s13, 144
    s_cmp_ge_u32 s13, 144
    s_cselect_b32 s13, s62, s13
    s_lshl_b32 m0, s13, 10
    s_mul_i32 s62, s13, 55296
    buffer_load_dwordx4 v15, s[36:39], s62 offen  lds
    s_add_u32 s13, s13, 8
    s_sub_u32 s62, s13, 144
    s_cmp_ge_u32 s13, 144
    s_cselect_b32 s13, s62, s13
    s_lshl_b32 m0, s13, 10
    s_mul_i32 s62, s13, 55296
    buffer_load_dwordx4 v15, s[36:39], s62 offen  lds
    s_add_u32 s13, s13, 8
    s_sub_u32 s62, s13, 144
    s_cmp_ge_u32 s13, 144
    s_cselect_b32 s13, s62, s13
    s_lshl_b32 m0, s13, 10
    s_mul_i32 s62, s13, 55296
    buffer_load_dwordx4 v15, s[36:39], s62 offen  lds
    s_add_u32 s13, s13, 8
    s_sub_u32 s62, s13, 144
    s_cmp_ge_u32 s13, 144
    s_cselect_b32 s13, s62, s13
    s_lshl_b32 m0, s13, 10
    s_mul_i32 s62, s13, 55296
    buffer_load_dwordx4 v15, s[36:39], s62 offen  lds
    s_add_u32 s13, s13, 8
    s_sub_u32 s62, s13, 144
    s_cmp_ge_u32 s13, 144
    s_cselect_b32 s13, s62, s13
L_b:
    s_mov_b32 s36, s22
    s_and_b32 s37, s23, 0xffff
    s_mov_b32 s38, 0x288000
    s_mov_b32 s39, 0x20000
    s_mov_b32 s32, s16
    s_and_b32 s33, s17, 0xffff
    s_mov_b32 s34, 0x120000
    s_mov_b32 s35, 0x20000
    s_sub_u32 s6, s6, 5
    s_and_b32 s52, s5, 3
    s_mul_i32 s52, s52, 18
    s_min_u32 s54, s6, 17
    s_add_u32 s52, s52, s54
    s_lshr_b32 s49, s52, 3
    s_and_b32 s54, s52, 7
    s_lshr_b32 s56, s5, 2
    s_lshl_b32 s48, s56, 3
    s_add_u32 s48, s48, s54
    s_and_b32 s50, s3, 3
    s_lshr_b32 s51, s3, 2
    s_lshl_b32 s57, s49, 7
    s_lshl_b32 s53, s48, 3
    s_add_u32 s53, s53, s3
    s_mul_i32 s53, s53, 9216
    s_lshl_b32 s52, s57, 1
    s_add_u32 s53, s53, s52
    v_lshrrev_b32 v235, 4, v0
    v_mul_u32_u24 v235, 2304, v235
    v_and_b32 v12, 15, v0
    v_lshl_add_u32 v235, v12, 4, v235
    s_mov_b32 s14, s53
    s_and_b32 s62, s5, 3
    s_mul_i32 s62, s62, 18
    s_add_u32 s62, s62, s6
    s_lshr_b32 s9, s62, 2
    s_and_b32 s62, s62, 3
    s_lshr_b32 s10, s5, 2
    s_lshl_b32 s10, s10, 2
    s_add_u32 s10, s10, s62
    s_lshl_b32 s10, s10, 1
    s_and_b32 s62, s3, 1
    s_add_u32 s10, s10, s62
    v_lshlrev_b32 v14, 4, v5
    v_mul_u32_u24 v9, 2304, v6
    s_lshl_b32 s62, s9, 7
    v_add3_u32 v14, v14, v9, s62
    s_lshl_b32 s49, s12, 2
    s_and_b32 s52, s3, 3
    s_add_u32 s49, s49, s52
    s_mul_i32 s53, s49, 73728
    s_add_u32 s53, s53, 131072
    v_mov_b32 v17, v3
    v_mov_b32 v18, v4
    v_min_u32 v9, 17, v0
    v_lshlrev_b32 v9, 7, v9
    s_lshr_b32 s52, s12, 1
    s_mul_i32 s52, s52, 2304
    s_add_u32 s52, s52, 8192
    s_mul_i32 s54, s49, 54
    s_add_u32 s54, s54, s11
    s_lshl_b32 s54, s54, 7
    s_add_u32 s54, s54, 7602176
    s_waitcnt vmcnt(0)
    s_barrier
    s_cmp_ge_u32 s3, 4
    s_cbranch_scc1 L_ld
L_gp_5:
    buffer_load_dword v10, v9, s[44:47], s52 offen sc1
    s_waitcnt vmcnt(0)
    v_cmp_ne_u32 vcc, s4, v10
    s_cbranch_vccz L_gpd_6
    s_sleep 2
    s_sub_u32 s7, s7, 1
    s_cmp_lg_u32 s7, 0
    s_cbranch_scc1 L_gp_5
    s_mov_b32 s7, 1
L_gpd_6:
    ds_read_b64_tr_b16 v[52:53], v17 offset:0
    ds_read_b64_tr_b16 v[54:55], v17 offset:512
    ds_read_b64_tr_b16 v[56:57], v18 offset:0
    ds_read_b64_tr_b16 v[58:59], v18 offset:512
    ds_read_b64_tr_b16 v[60:61], v17 offset:2048
    ds_read_b64_tr_b16 v[62:63], v17 offset:2560
    ds_read_b64_tr_b16 v[64:65], v18 offset:2048
    ds_read_b64_tr_b16 v[66:67], v18 offset:2560
    buffer_load_dwordx4 v[84:87], v1, s[44:47], s53 offen offset:0 sc1
    buffer_load_dwordx4 v[88:91], v1, s[44:47], s53 offen offset:1024 sc1
    buffer_load_dwordx4 v[92:95], v1, s[44:47], s53 offen offset:2048 sc1
    buffer_load_dwordx4 v[96:99], v1, s[44:47], s53 offen offset:3072 sc1
    s_add_u32 s53, s53, 4096
    buffer_load_dwordx4 v[100:103], v1, s[44:47], s53 offen offset:0 sc1
    buffer_load_dwordx4 v[104:107], v1, s[44:47], s53 offen offset:1024 sc1
    buffer_load_dwordx4 v[108:111], v1, s[44:47], s53 offen offset:2048 sc1
    buffer_load_dwordx4 v[112:115], v1, s[44:47], s53 offen offset:3072 sc1
    s_add_u32 s53, s53, 4096
    buffer_load_dwordx4 v[116:119], v1, s[44:47], s53 offen offset:0 sc1
    buffer_load_dwordx4 v[120:123], v1, s[44:47], s53 offen offset:1024 sc1
    buffer_load_dwordx4 v[124:127], v1, s[44:47], s53 offen offset:2048 sc1
    buffer_load_dwordx4 v[128:131], v1, s[44:47], s53 offen offset:3072 sc1
    s_add_u32 s53, s53, 4096
    s_waitcnt vmcnt(11) lgkmcnt(4)
    v_mfma_f32_32x32x16_bf16 v[20:35], v[52:55], v[84:87], 0
    ds_read_b64_tr_b16 v[68:69], v17 offset:4096
    ds_read_b64_tr_b16 v[70:71], v17 offset:4608
    ds_read_b64_tr_b16 v[72:73], v18 offset:4096
    ds_read_b64_tr_b16 v[74:75], v18 offset:4608
    v_mfma_f32_32x32x16_bf16 v[36:51], v[56:59], v[84:87], 0
    buffer_load_dwordx4 v[132:135], v1, s[44:47], s53 offen offset:0 sc1
    s_waitcnt vmcnt(11) lgkmcnt(4)
    v_mfma_f32_32x32x16_bf16 v[20:35], v[60:63], v[88:91], v[20:35]
    ds_read_b64_tr_b16 v[76:77], v17 offset:6144
    ds_read_b64_tr_b16 v[78:79], v17 offset:6656
    ds_read_b64_tr_b16 v[80:81], v18 offset:6144
    ds_read_b64_tr_b16 v[82:83], v18 offset:6656
    v_mfma_f32_32x32x16_bf16 v[36:51], v[64:67], v[88:91], v[36:51]
    buffer_load_dwordx4 v[136:139], v1, s[44:47], s53 offen offset:1024 sc1
    s_waitcnt vmcnt(11) lgkmcnt(4)
    v_mfma_f32_32x32x16_bf16 v[20:35], v[68:71], v[92:95], v[20:35]
    ds_read_b64_tr_b16 v[52:53], v17 offset:8192
    ds_read_b64_tr_b16 v[54:55], v17 offset:8704
    ds_read_b64_tr_b16 v[56:57], v18 offset:8192
    ds_read_b64_tr_b16 v[58:59], v18 offset:8704
    v_mfma_f32_32x32x16_bf16 v[36:51], v[72:75], v[92:95], v[36:51]
    buffer_load_dwordx4 v[140:143], v1, s[44:47], s53 offen offset:2048 sc1
    s_waitcnt vmcnt(11) lgkmcnt(4)
    v_mfma_f32_32x32x16_bf16 v[20:35], v[76:79], v[96:99], v[20:35]
    ds_read_b64_tr_b16 v[60:61], v17 offset:10240
    ds_read_b64_tr_b16 v[62:63], v17 offset:10752
    ds_read_b64_tr_b16 v[64:65], v18 offset:10240
    ds_read_b64_tr_b16 v[66:67], v18 offset:10752
    v_mfma_f32_32x32x16_bf16 v[36:51], v[80:83], v[96:99], v[36:51]
    buffer_load_dwordx4 v[144:147], v1, s[44:47], s53 offen offset:3072 sc1
    s_add_u32 s53, s53, 4096
    s_waitcnt vmcnt(11) lgkmcnt(4)
    v_mfma_f32_32x32x16_bf16 v[20:35], v[52:55], v[100:103], v[20:35]
    ds_read_b64_tr_b16 v[68:69], v17 offset:12288
    ds_read_b64_tr_b16 v[70:71], v17 offset:12800
    ds_read_b64_tr_b16 v[72:73], v18 offset:12288
    ds_read_b64_tr_b16 v[74:75], v18 offset:12800
    v_mfma_f32_32x32x16_bf16 v[36:51], v[56:59], v[100:103], v[36:51]
    buffer_load_dwordx4 v[84:87], v1, s[44:47], s53 offen offset:0 sc1
    s_waitcnt vmcnt(11) lgkmcnt(4)
    v_mfma_f32_32x32x16_bf16 v[20:35], v[60:63], v[104:107], v[20:35]
    ds_read_b64_tr_b16 v[76:77], v17 offset:14336
    ds_read_b64_tr_b16 v[78:79], v17 offset:14848
    ds_read_b64_tr_b16 v[80:81], v18 offset:14336
    ds_read_b64_tr_b16 v[82:83], v18 offset:14848
    v_mfma_f32_32x32x16_bf16 v[36:51], v[64:67], v[104:107], v[36:51]
    buffer_load_dwordx4 v[88:91], v1, s[44:47], s53 offen offset:1024 sc1
    s_waitcnt vmcnt(11) lgkmcnt(4)
    v_mfma_f32_32x32x16_bf16 v[20:35], v[68:71], v[108:111], v[20:35]
    ds_read_b64_tr_b16 v[52:53], v17 offset:16384
    ds_read_b64_tr_b16 v[54:55], v17 offset:16896
    ds_read_b64_tr_b16 v[56:57], v18 offset:16384
    ds_read_b64_tr_b16 v[58:59], v18 offset:16896
    v_mfma_f32_32x32x16_bf16 v[36:51], v[72:75], v[108:111], v[36:51]
    buffer_load_dwordx4 v[92:95], v1, s[44:47], s53 offen offset:2048 sc1
    s_waitcnt vmcnt(11) lgkmcnt(4)
    v_mfma_f32_32x32x16_bf16 v[20:35], v[76:79], v[112:115], v[20:35]
    ds_read_b64_tr_b16 v[60:61], v17 offset:18432
    ds_read_b64_tr_b16 v[62:63], v17 offset:18944
    ds_read_b64_tr_b16 v[64:65], v18 offset:18432
    ds_read_b64_tr_b16 v[66:67], v18 offset:18944
    v_mfma_f32_32x32x16_bf16 v[36:51], v[80:83], v[112:115], v[36:51]
    buffer_load_dwordx4 v[96:99], v1, s[44:47], s53 offen offset:3072 sc1
    s_add_u32 s53, s53, 4096
    s_waitcnt vmcnt(11) lgkmcnt(4)
    v_mfma_f32_32x32x16_bf16 v[20:35], v[52:55], v[116:119], v[20:35]
    ds_read_b64_tr_b16 v[68:69], v17 offset:20480
    ds_read_b64_tr_b16 v[70:71], v17 offset:20992
    ds_read_b64_tr_b16 v[72:73], v18 offset:20480
    ds_read_b64_tr_b16 v[74:75], v18 offset:20992
    v_mfma_f32_32x32x16_bf16 v[36:51], v[56:59], v[116:119], v[36:51]
    buffer_load_dwordx4 v[100:103], v1, s[44:47], s53 offen offset:0 sc1
    s_waitcnt vmcnt(11) lgkmcnt(4)
    v_mfma_f32_32x32x16_bf16 v[20:35], v[60:63], v[120:123], v[20:35]
    ds_read_b64_tr_b16 v[76:77], v17 offset:22528
    ds_read_b64_tr_b16 v[78:79], v17 offset:23040
    ds_read_b64_tr_b16 v[80:81], v18 offset:22528
    ds_read_b64_tr_b16 v[82:83], v18 offset:23040
    v_mfma_f32_32x32x16_bf16 v[36:51], v[64:67], v[120:123], v[36:51]
    buffer_load_dwordx4 v[104:107], v1, s[44:47], s53 offen offset:1024 sc1
    s_waitcnt vmcnt(11) lgkmcnt(4)
    v_mfma_f32_32x32x16_bf16 v[20:35], v[68:71], v[124:127], v[20:35]
    ds_read_b64_tr_b16 v[52:53], v17 offset:24576
    ds_read_b64_tr_b16 v[54:55], v17 offset:25088
    ds_read_b64_tr_b16 v[56:57], v18 offset:24576
    ds_read_b64_tr_b16 v[58:59], v18 offset:25088
    v_mfma_f32_32x32x16_bf16 v[36:51], v[72:75], v[124:127], v[36:51]
    buffer_load_dwordx4 v[108:111], v1, s[44:47], s53 offen offset:2048 sc1
    s_waitcnt vmcnt(11) lgkmcnt(4)
    v_mfma_f32_32x32x16_bf16 v[20:35], v[76:79], v[128:131], v[20:35]
    ds_read_b64_tr_b16 v[60:61], v17 offset:26624
    ds_read_b64_tr_b16 v[62:63], v17 offset:27136
    ds_read_b64_tr_b16 v[64:65], v18 offset:26624
    ds_read_b64_tr_b16 v[66:67], v18 offset:27136
    v_mfma_f32_32x32x16_bf16 v[36:51], v[80:83], v[128:131], v[36:51]
    buffer_load_dwordx4 v[112:115], v1, s[44:47], s53 offen offset:3072 sc1
    s_add_u32 s53, s53, 4096
    s_waitcnt vmcnt(11) lgkmcnt(4)
    v_mfma_f32_32x32x16_bf16 v[20:35], v[52:55], v[132:135], v[20:35]
    ds_read_b64_tr_b16 v[68:69], v17 offset:28672
    ds_read_b64_tr_b16 v[70:71], v17 offset:29184
    ds_read_b64_tr_b16 v[72:73], v18 offset:28672
    ds_read_b64_tr_b16 v[74:75], v18 offset:29184
    v_mfma_f32_32x32x16_bf16 v[36:51], v[56:59], v[132:135], v[36:51]
    buffer_load_dwordx4 v[116:119], v1, s[44:47], s53 offen offset:0 sc1
    s_waitcnt vmcnt(11) lgkmcnt(4)
    v_mfma_f32_32x32x16_bf16 v[20:35], v[60:63], v[136:139], v[20:35]
    ds_read_b64_tr_b16 v[76:77], v17 offset:30720
    ds_read_b64_tr_b16 v[78:79], v17 offset:31232
    ds_read_b64_tr_b16 v[80:81], v18 offset:30720
    ds_read_b64_tr_b16 v[82:83], v18 offset:31232
    v_mfma_f32_32x32x16_bf16 v[36:51], v[64:67], v[136:139], v[36:51]
    buffer_load_dwordx4 v[120:123], v1, s[44:47], s53 offen offset:1024 sc1
    s_waitcnt vmcnt(11) lgkmcnt(4)
    v_mfma_f32_32x32x16_bf16 v[20:35], v[68:71], v[140:143], v[20:35]
    ds_read_b64_tr_b16 v[52:53], v17 offset:32768
    ds_read_b64_tr_b16 v[54:55], v17 offset:33280
    ds_read_b64_tr_b16 v[56:57], v18 offset:32768
    ds_read_b64_tr_b16 v[58:59], v18 offset:33280
    v_mfma_f32_32x32x16_bf16 v[36:51], v[72:75], v[140:143], v[36:51]
    buffer_load_dwordx4 v[124:127], v1, s[44:47], s53 offen offset:2048 sc1
    s_waitcnt vmcnt(11) lgkmcnt(4)
    v_mfma_f32_32x32x16_bf16 v[20:35], v[76:79], v[144:147], v[20:35]
    ds_read_b64_tr_b16 v[60:61], v17 offset:34816
    ds_read_b64_tr_b16 v[62:63], v17 offset:35328
    ds_read_b64_tr_b16 v[64:65], v18 offset:34816
    ds_read_b64_tr_b16 v[66:67], v18 offset:35328
    v_mfma_f32_32x32x16_bf16 v[36:51], v[80:83], v[144:147], v[36:51]
    buffer_load_dwordx4 v[128:131], v1, s[44:47], s53 offen offset:3072 sc1
    s_add_u32 s53, s53, 4096
    s_waitcnt vmcnt(11) lgkmcnt(4)
    v_mfma_f32_32x32x16_bf16 v[20:35], v[52:55], v[84:87], v[20:35]
    ds_read_b64_tr_b16 v[68:69], v17 offset:36864
    ds_read_b64_tr_b16 v[70:71], v17 offset:37376
    ds_read_b64_tr_b16 v[72:73], v18 offset:36864
    ds_read_b64_tr_b16 v[74:75], v18 offset:37376
    v_mfma_f32_32x32x16_bf16 v[36:51], v[56:59], v[84:87], v[36:51]
    buffer_load_dwordx4 v[132:135], v1, s[44:47], s53 offen offset:0 sc1
    s_waitcnt vmcnt(11) lgkmcnt(4)
    v_mfma_f32_32x32x16_bf16 v[20:35], v[60:63], v[88:91], v[20:35]
    ds_read_b64_tr_b16 v[76:77], v17 offset:38912
    ds_read_b64_tr_b16 v[78:79], v17 offset:39424
    ds_read_b64_tr_b16 v[80:81], v18 offset:38912
    ds_read_b64_tr_b16 v[82:83], v18 offset:39424
    v_mfma_f32_32x32x16_bf16 v[36:51], v[64:67], v[88:91], v[36:51]
    buffer_load_dwordx4 v[136:139], v1, s[44:47], s53 offen offset:1024 sc1
    s_waitcnt vmcnt(11) lgkmcnt(4)
    v_mfma_f32_32x32x16_bf16 v[20:35], v[68:71], v[92:95], v[20:35]
    ds_read_b64_tr_b16 v[52:53], v17 offset:40960
    ds_read_b64_tr_b16 v[54:55], v17 offset:41472
    ds_read_b64_tr_b16 v[56:57], v18 offset:40960
    ds_read_b64_tr_b16 v[58:59], v18 offset:41472
    v_mfma_f32_32x32x16_bf16 v[36:51], v[72:75], v[92:95], v[36:51]
    buffer_load_dwordx4 v[140:143], v1, s[44:47], s53 offen offset:2048 sc1
    s_waitcnt vmcnt(11) lgkmcnt(4)
    v_mfma_f32_32x32x16_bf16 v[20:35], v[76:79], v[96:99], v[20:35]
    ds_read_b64_tr_b16 v[60:61], v17 offset:43008
    ds_read_b64_tr_b16 v[62:63], v17 offset:43520
    ds_read_b64_tr_b16 v[64:65], v18 offset:43008
    ds_read_b64_tr_b16 v[66:67], v18 offset:43520
    v_mfma_f32_32x32x16_bf16 v[36:51], v[80:83], v[96:99], v[36:51]
    buffer_load_dwordx4 v[144:147], v1, s[44:47], s53 offen offset:3072 sc1
    s_add_u32 s53, s53, 4096
    s_waitcnt vmcnt(11) lgkmcnt(4)
    v_mfma_f32_32x32x16_bf16 v[20:35], v[52:55], v[100:103], v[20:35]
    ds_read_b64_tr_b16 v[68:69], v17 offset:45056
    ds_read_b64_tr_b16 v[70:71], v17 offset:45568
    ds_read_b64_tr_b16 v[72:73], v18 offset:45056
    ds_read_b64_tr_b16 v[74:75], v18 offset:45568
    v_mfma_f32_32x32x16_bf16 v[36:51], v[56:59], v[100:103], v[36:51]
    buffer_load_dwordx4 v[84:87], v1, s[44:47], s53 offen offset:0 sc1
    s_waitcnt vmcnt(11) lgkmcnt(4)
    v_mfma_f32_32x32x16_bf16 v[20:35], v[60:63], v[104:107], v[20:35]
    ds_read_b64_tr_b16 v[76:77], v17 offset:47104
    ds_read_b64_tr_b16 v[78:79], v17 offset:47616
    ds_read_b64_tr_b16 v[80:81], v18 offset:47104
    ds_read_b64_tr_b16 v[82:83], v18 offset:47616
    v_mfma_f32_32x32x16_bf16 v[36:51], v[64:67], v[104:107], v[36:51]
    buffer_load_dwordx4 v[88:91], v1, s[44:47], s53 offen offset:1024 sc1
    s_waitcnt vmcnt(11) lgkmcnt(4)
    v_mfma_f32_32x32x16_bf16 v[20:35], v[68:71], v[108:111], v[20:35]
    ds_read_b64_tr_b16 v[52:53], v17 offset:49152
    ds_read_b64_tr_b16 v[54:55], v17 offset:49664
    ds_read_b64_tr_b16 v[56:57], v18 offset:49152
    ds_read_b64_tr_b16 v[58:59], v18 offset:49664
    v_mfma_f32_32x32x16_bf16 v[36:51], v[72:75], v[108:111], v[36:51]
    buffer_load_dwordx4 v[92:95], v1, s[44:47], s53 offen offset:2048 sc1
    s_waitcnt vmcnt(11) lgkmcnt(4)
    v_mfma_f32_32x32x16_bf16 v[20:35], v[76:79], v[112:115], v[20:35]
    ds_read_b64_tr_b16 v[60:61], v17 offset:51200
    ds_read_b64_tr_b16 v[62:63], v17 offset:51712
    ds_read_b64_tr_b16 v[64:65], v18 offset:51200
    ds_read_b64_tr_b16 v[66:67], v18 offset:51712
    v_mfma_f32_32x32x16_bf16 v[36:51], v[80:83], v[112:115], v[36:51]
    buffer_load_dwordx4 v[96:99], v1, s[44:47], s53 offen offset:3072 sc1
    s_add_u32 s53, s53, 4096
    s_waitcnt vmcnt(11) lgkmcnt(4)
    v_mfma_f32_32x32x16_bf16 v[20:35], v[52:55], v[116:119], v[20:35]
    ds_read_b64_tr_b16 v[68:69], v17 offset:53248
    ds_read_b64_tr_b16 v[70:71], v17 offset:53760
    ds_read_b64_tr_b16 v[72:73], v18 offset:53248
    ds_read_b64_tr_b16 v[74:75], v18 offset:53760
    v_mfma_f32_32x32x16_bf16 v[36:51], v[56:59], v[116:119], v[36:51]
    buffer_load_dwordx4 v[100:103], v1, s[44:47], s53 offen offset:0 sc1
    s_waitcnt vmcnt(11) lgkmcnt(4)
    v_mfma_f32_32x32x16_bf16 v[20:35], v[60:63], v[120:123], v[20:35]
    ds_read_b64_tr_b16 v[76:77], v17 offset:55296
    ds_read_b64_tr_b16 v[78:79], v17 offset:55808
    ds_read_b64_tr_b16 v[80:81], v18 offset:55296
    ds_read_b64_tr_b16 v[82:83], v18 offset:55808
    v_mfma_f32_32x32x16_bf16 v[36:51], v[64:67], v[120:123], v[36:51]
    buffer_load_dwordx4 v[104:107], v1, s[44:47], s53 offen offset:1024 sc1
    s_waitcnt vmcnt(11) lgkmcnt(4)
    v_mfma_f32_32x32x16_bf16 v[20:35], v[68:71], v[124:127], v[20:35]
    ds_read_b64_tr_b16 v[52:53], v17 offset:57344
    ds_read_b64_tr_b16 v[54:55], v17 offset:57856
    ds_read_b64_tr_b16 v[56:57], v18 offset:57344
    ds_read_b64_tr_b16 v[58:59], v18 offset:57856
    v_mfma_f32_32x32x16_bf16 v[36:51], v[72:75], v[124:127], v[36:51]
    buffer_load_dwordx4 v[108:111], v1, s[44:47], s53 offen offset:2048 sc1
    s_waitcnt vmcnt(11) lgkmcnt(4)
    v_mfma_f32_32x32x16_bf16 v[20:35], v[76:79], v[128:131], v[20:35]
    ds_read_b64_tr_b16 v[60:61], v17 offset:59392
    ds_read_b64_tr_b16 v[62:63], v17 offset:59904
    ds_read_b64_tr_b16 v[64:65], v18 offset:59392
    ds_read_b64_tr_b16 v[66:67], v18 offset:59904
    v_mfma_f32_32x32x16_bf16 v[36:51], v[80:83], v[128:131], v[36:51]
    buffer_load_dwordx4 v[112:115], v1, s[44:47], s53 offen offset:3072 sc1
    s_add_u32 s53, s53, 4096
    s_waitcnt vmcnt(11) lgkmcnt(4)
    v_mfma_f32_32x32x16_bf16 v[20:35], v[52:55], v[132:135], v[20:35]
    ds_read_b64_tr_b16 v[68:69], v17 offset:61440
    ds_read_b64_tr_b16 v[70:71], v17 offset:61952
    ds_read_b64_tr_b16 v[72:73], v18 offset:61440
    ds_read_b64_tr_b16 v[74:75], v18 offset:61952
    v_mfma_f32_32x32x16_bf16 v[36:51], v[56:59], v[132:135], v[36:51]
    buffer_load_dwordx4 v[116:119], v1, s[44:47], s53 offen offset:0 sc1
    s_waitcnt vmcnt(11) lgkmcnt(4)
    v_mfma_f32_32x32x16_bf16 v[20:35], v[60:63], v[136:139], v[20:35]
    ds_read_b64_tr_b16 v[76:77], v17 offset:63488
    ds_read_b64_tr_b16 v[78:79], v17 offset:64000
    ds_read_b64_tr_b16 v[80:81], v18 offset:63488
    ds_read_b64_tr_b16 v[82:83], v18 offset:64000
    v_mfma_f32_32x32x16_bf16 v[36:51], v[64:67], v[136:139], v[36:51]
    buffer_load_dwordx4 v[120:123], v1, s[44:47], s53 offen offset:1024 sc1
    s_waitcnt vmcnt(11) lgkmcnt(4)
    v_mfma_f32_32x32x16_bf16 v[20:35], v[68:71], v[140:143], v[20:35]
    v_add_u32 v17, 0x10000, v17
    v_add_u32 v18, 0x10000, v18
    ds_read_b64_tr_b16 v[52:53], v17 offset:0
    ds_read_b64_tr_b16 v[54:55], v17 offset:512
    ds_read_b64_tr_b16 v[56:57], v18 offset:0
    ds_read_b64_tr_b16 v[58:59], v18 offset:512
    v_mfma_f32_32x32x16_bf16 v[36:51], v[72:75], v[140:143], v[36:51]
    buffer_load_dwordx4 v[124:127], v1, s[44:47], s53 offen offset:2048 sc1
    s_waitcnt vmcnt(11) lgkmcnt(4)
    v_mfma_f32_32x32x16_bf16 v[20:35], v[76:79], v[144:147], v[20:35]
    ds_read_b64_tr_b16 v[60:61], v17 offset:2048
    ds_read_b64_tr_b16 v[62:63], v17 offset:2560
    ds_read_b64_tr_b16 v[64:65], v18 offset:2048
    ds_read_b64_tr_b16 v[66:67], v18 offset:2560
    v_mfma_f32_32x32x16_bf16 v[36:51], v[80:83], v[144:147], v[36:51]
    buffer_load_dwordx4 v[128:131], v1, s[44:47], s53 offen offset:3072 sc1
    s_add_u32 s53, s53, 4096
    s_waitcnt vmcnt(11) lgkmcnt(4)
    v_mfma_f32_32x32x16_bf16 v[20:35], v[52:55], v[84:87], v[20:35]
    ds_read_b64_tr_b16 v[68:69], v17 offset:4096
    ds_read_b64_tr_b16 v[70:71], v17 offset:4608
    ds_read_b64_tr_b16 v[72:73], v18 offset:4096
    ds_read_b64_tr_b16 v[74:75], v18 offset:4608
    v_mfma_f32_32x32x16_bf16 v[36:51], v[56:59], v[84:87], v[36:51]
    buffer_load_dwordx4 v[132:135], v1, s[44:47], s53 offen offset:0 sc1
    s_waitcnt vmcnt(11) lgkmcnt(4)
    v_mfma_f32_32x32x16_bf16 v[20:35], v[60:63], v[88:91], v[20:35]
    ds_read_b64_tr_b16 v[76:77], v17 offset:6144
    ds_read_b64_tr_b16 v[78:79], v17 offset:6656
    ds_read_b64_tr_b16 v[80:81], v18 offset:6144
    ds_read_b64_tr_b16 v[82:83], v18 offset:6656
    v_mfma_f32_32x32x16_bf16 v[36:51], v[64:67], v[88:91], v[36:51]
    buffer_load_dwordx4 v[136:139], v1, s[44:47], s53 offen offset:1024 sc1
    s_waitcnt vmcnt(11) lgkmcnt(4)
    v_mfma_f32_32x32x16_bf16 v[20:35], v[68:71], v[92:95], v[20:35]
    ds_read_b64_tr_b16 v[52:53], v17 offset:8192
    ds_read_b64_tr_b16 v[54:55], v17 offset:8704
    ds_read_b64_tr_b16 v[56:57], v18 offset:8192
    ds_read_b64_tr_b16 v[58:59], v18 offset:8704
    v_mfma_f32_32x32x16_bf16 v[36:51], v[72:75], v[92:95], v[36:51]
    buffer_load_dwordx4 v[140:143], v1, s[44:47], s53 offen offset:2048 sc1
    s_waitcnt vmcnt(11) lgkmcnt(4)
    v_mfma_f32_32x32x16_bf16 v[20:35], v[76:79], v[96:99], v[20:35]
    ds_read_b64_tr_b16 v[60:61], v17 offset:10240
    ds_read_b64_tr_b16 v[62:63], v17 offset:10752
    ds_read_b64_tr_b16 v[64:65], v18 offset:10240
    ds_read_b64_tr_b16 v[66:67], v18 offset:10752
    v_mfma_f32_32x32x16_bf16 v[36:51], v[80:83], v[96:99], v[36:51]
    buffer_load_dwordx4 v[144:147], v1, s[44:47], s53 offen offset:3072 sc1
    s_add_u32 s53, s53, 4096
    s_waitcnt vmcnt(11) lgkmcnt(4)
    v_mfma_f32_32x32x16_bf16 v[20:35], v[52:55], v[100:103], v[20:35]
    ds_read_b64_tr_b16 v[68:69], v17 offset:12288
    ds_read_b64_tr_b16 v[70:71], v17 offset:12800
    ds_read_b64_tr_b16 v[72:73], v18 offset:12288
    ds_read_b64_tr_b16 v[74:75], v18 offset:12800
    v_mfma_f32_32x32x16_bf16 v[36:51], v[56:59], v[100:103], v[36:51]
    buffer_load_dwordx4 v[84:87], v1, s[44:47], s53 offen offset:0 sc1
    s_waitcnt vmcnt(11) lgkmcnt(4)
    v_mfma_f32_32x32x16_bf16 v[20:35], v[60:63], v[104:107], v[20:35]
    ds_read_b64_tr_b16 v[76:77], v17 offset:14336
    ds_read_b64_tr_b16 v[78:79], v17 offset:14848
    ds_read_b64_tr_b16 v[80:81], v18 offset:14336
    ds_read_b64_tr_b16 v[82:83], v18 offset:14848
    v_mfma_f32_32x32x16_bf16 v[36:51], v[64:67], v[104:107], v[36:51]
    buffer_load_dwordx4 v[88:91], v1, s[44:47], s53 offen offset:1024 sc1
    s_waitcnt vmcnt(11) lgkmcnt(4)
    v_mfma_f32_32x32x16_bf16 v[20:35], v[68:71], v[108:111], v[20:35]
    ds_read_b64_tr_b16 v[52:53], v17 offset:16384
    ds_read_b64_tr_b16 v[54:55], v17 offset:16896
    ds_read_b64_tr_b16 v[56:57], v18 offset:16384
    ds_read_b64_tr_b16 v[58:59], v18 offset:16896
    v_mfma_f32_32x32x16_bf16 v[36:51], v[72:75], v[108:111], v[36:51]
    buffer_load_dwordx4 v[92:95], v1, s[44:47], s53 offen offset:2048 sc1
    s_waitcnt vmcnt(11) lgkmcnt(4)
    v_mfma_f32_32x32x16_bf16 v[20:35], v[76:79], v[112:115], v[20:35]
    ds_read_b64_tr_b16 v[60:61], v17 offset:18432
    ds_read_b64_tr_b16 v[62:63], v17 offset:18944
    ds_read_b64_tr_b16 v[64:65], v18 offset:18432
    ds_read_b64_tr_b16 v[66:67], v18 offset:18944
    v_mfma_f32_32x32x16_bf16 v[36:51], v[80:83], v[112:115], v[36:51]
    buffer_load_dwordx4 v[96:99], v1, s[44:47], s53 offen offset:3072 sc1
    s_add_u32 s53, s53, 4096
    s_waitcnt vmcnt(11) lgkmcnt(4)
    v_mfma_f32_32x32x16_bf16 v[20:35], v[52:55], v[116:119], v[20:35]
    ds_read_b64_tr_b16 v[68:69], v17 offset:20480
    ds_read_b64_tr_b16 v[70:71], v17 offset:20992
    ds_read_b64_tr_b16 v[72:73], v18 offset:20480
    ds_read_b64_tr_b16 v[74:75], v18 offset:20992
    v_mfma_f32_32x32x16_bf16 v[36:51], v[56:59], v[116:119], v[36:51]
    buffer_load_dwordx4 v[100:103], v1, s[44:47], s53 offen offset:0 sc1
    s_waitcnt vmcnt(11) lgkmcnt(4)
    v_mfma_f32_32x32x16_bf16 v[20:35], v[60:63], v[120:123], v[20:35]
    ds_read_b64_tr_b16 v[76:77], v17 offset:22528
    ds_read_b64_tr_b16 v[78:79], v17 offset:23040
    ds_read_b64_tr_b16 v[80:81], v18 offset:22528
    ds_read_b64_tr_b16 v[82:83], v18 offset:23040
    v_mfma_f32_32x32x16_bf16 v[36:51], v[64:67], v[120:123], v[36:51]
    buffer_load_dwordx4 v[104:107], v1, s[44:47], s53 offen offset:1024 sc1
    s_waitcnt vmcnt(11) lgkmcnt(4)
    v_mfma_f32_32x32x16_bf16 v[20:35], v[68:71], v[124:127], v[20:35]
    ds_read_b64_tr_b16 v[52:53], v17 offset:24576
    ds_read_b64_tr_b16 v[54:55], v17 offset:25088
    ds_read_b64_tr_b16 v[56:57], v18 offset:24576
    ds_read_b64_tr_b16 v[58:59], v18 offset:25088
    v_mfma_f32_32x32x16_bf16 v[36:51], v[72:75], v[124:127], v[36:51]
    buffer_load_dwordx4 v[108:111], v1, s[44:47], s53 offen offset:2048 sc1
    s_waitcnt vmcnt(11) lgkmcnt(4)
    v_mfma_f32_32x32x16_bf16 v[20:35], v[76:79], v[128:131], v[20:35]
    ds_read_b64_tr_b16 v[60:61], v17 offset:26624
    ds_read_b64_tr_b16 v[62:63], v17 offset:27136
    ds_read_b64_tr_b16 v[64:65], v18 offset:26624
    ds_read_b64_tr_b16 v[66:67], v18 offset:27136
    v_mfma_f32_32x32x16_bf16 v[36:51], v[80:83], v[128:131], v[36:51]
    buffer_load_dwordx4 v[112:115], v1, s[44:47], s53 offen offset:3072 sc1
    s_add_u32 s53, s53, 4096
    s_waitcnt vmcnt(11) lgkmcnt(4)
    v_mfma_f32_32x32x16_bf16 v[20:35], v[52:55], v[132:135], v[20:35]
    ds_read_b64_tr_b16 v[68:69], v17 offset:28672
    ds_read_b64_tr_b16 v[70:71], v17 offset:29184
    ds_read_b64_tr_b16 v[72:73], v18 offset:28672
    ds_read_b64_tr_b16 v[74:75], v18 offset:29184
    v_mfma_f32_32x32x16_bf16 v[36:51], v[56:59], v[132:135], v[36:51]
    buffer_load_dwordx4 v[116:119], v1, s[44:47], s53 offen offset:0 sc1
    s_waitcnt vmcnt(11) lgkmcnt(4)
    v_mfma_f32_32x32x16_bf16 v[20:35], v[60:63], v[136:139], v[20:35]
    ds_read_b64_tr_b16 v[76:77], v17 offset:30720
    ds_read_b64_tr_b16 v[78:79], v17 offset:31232
    ds_read_b64_tr_b16 v[80:81], v18 offset:30720
    ds_read_b64_tr_b16 v[82:83], v18 offset:31232
    v_mfma_f32_32x32x16_bf16 v[36:51], v[64:67], v[136:139], v[36:51]
    buffer_load_dwordx4 v[120:123], v1, s[44:47], s53 offen offset:1024 sc1
    s_waitcnt vmcnt(11) lgkmcnt(4)
    v_mfma_f32_32x32x16_bf16 v[20:35], v[68:71], v[140:143], v[20:35]
    ds_read_b64_tr_b16 v[52:53], v17 offset:32768
    ds_read_b64_tr_b16 v[54:55], v17 offset:33280
    ds_read_b64_tr_b16 v[56:57], v18 offset:32768
    ds_read_b64_tr_b16 v[58:59], v18 offset:33280
    v_mfma_f32_32x32x16_bf16 v[36:51], v[72:75], v[140:143], v[36:51]
    buffer_load_dwordx4 v[124:127], v1, s[44:47], s53 offen offset:2048 sc1
    s_waitcnt vmcnt(11) lgkmcnt(4)
    v_mfma_f32_32x32x16_bf16 v[20:35], v[76:79], v[144:147], v[20:35]
    ds_read_b64_tr_b16 v[60:61], v17 offset:34816
    ds_read_b64_tr_b16 v[62:63], v17 offset:35328
    ds_read_b64_tr_b16 v[64:65], v18 offset:34816
    ds_read_b64_tr_b16 v[66:67], v18 offset:35328
    v_mfma_f32_32x32x16_bf16 v[36:51], v[80:83], v[144:147], v[36:51]
    buffer_load_dwordx4 v[128:131], v1, s[44:47], s53 offen offset:3072 sc1
    s_add_u32 s53, s53, 4096
    s_waitcnt vmcnt(11) lgkmcnt(4)
    v_mfma_f32_32x32x16_bf16 v[20:35], v[52:55], v[84:87], v[20:35]
    ds_read_b64_tr_b16 v[68:69], v17 offset:36864
    ds_read_b64_tr_b16 v[70:71], v17 offset:37376
    ds_read_b64_tr_b16 v[72:73], v18 offset:36864
    ds_read_b64_tr_b16 v[74:75], v18 offset:37376
    v_mfma_f32_32x32x16_bf16 v[36:51], v[56:59], v[84:87], v[36:51]
    buffer_load_dwordx4 v[132:135], v1, s[44:47], s53 offen offset:0 sc1
    s_waitcnt vmcnt(11) lgkmcnt(4)
    v_mfma_f32_32x32x16_bf16 v[20:35], v[60:63], v[88:91], v[20:35]
    ds_read_b64_tr_b16 v[76:77], v17 offset:38912
    ds_read_b64_tr_b16 v[78:79], v17 offset:39424
    ds_read_b64_tr_b16 v[80:81], v18 offset:38912
    ds_read_b64_tr_b16 v[82:83], v18 offset:39424
    v_mfma_f32_32x32x16_bf16 v[36:51], v[64:67], v[88:91], v[36:51]
    buffer_load_dwordx4 v[136:139], v1, s[44:47], s53 offen offset:1024 sc1
    s_waitcnt vmcnt(11) lgkmcnt(4)
    v_mfma_f32_32x32x16_bf16 v[20:35], v[68:71], v[92:95], v[20:35]
    ds_read_b64_tr_b16 v[52:53], v17 offset:40960
    ds_read_b64_tr_b16 v[54:55], v17 offset:41472
    ds_read_b64_tr_b16 v[56:57], v18 offset:40960
    ds_read_b64_tr_b16 v[58:59], v18 offset:41472
    v_mfma_f32_32x32x16_bf16 v[36:51], v[72:75], v[92:95], v[36:51]
    buffer_load_dwordx4 v[140:143], v1, s[44:47], s53 offen offset:2048 sc1
    s_waitcnt vmcnt(11) lgkmcnt(4)
    v_mfma_f32_32x32x16_bf16 v[20:35], v[76:79], v[96:99], v[20:35]
    ds_read_b64_tr_b16 v[60:61], v17 offset:43008
    ds_read_b64_tr_b16 v[62:63], v17 offset:43520
    ds_read_b64_tr_b16 v[64:65], v18 offset:43008
    ds_read_b64_tr_b16 v[66:67], v18 offset:43520
    v_mfma_f32_32x32x16_bf16 v[36:51], v[80:83], v[96:99], v[36:51]
    buffer_load_dwordx4 v[144:147], v1, s[44:47], s53 offen offset:3072 sc1
    s_add_u32 s53, s53, 4096
    s_waitcnt vmcnt(11) lgkmcnt(4)
    v_mfma_f32_32x32x16_bf16 v[20:35], v[52:55], v[100:103], v[20:35]
    ds_read_b64_tr_b16 v[68:69], v17 offset:45056
    ds_read_b64_tr_b16 v[70:71], v17 offset:45568
    ds_read_b64_tr_b16 v[72:73], v18 offset:45056
    ds_read_b64_tr_b16 v[74:75], v18 offset:45568
    v_mfma_f32_32x32x16_bf16 v[36:51], v[56:59], v[100:103], v[36:51]
    buffer_load_dwordx4 v[84:87], v1, s[44:47], s53 offen offset:0 sc1
    s_waitcnt vmcnt(11) lgkmcnt(4)
    v_mfma_f32_32x32x16_bf16 v[20:35], v[60:63], v[104:107], v[20:35]
    ds_read_b64_tr_b16 v[76:77], v17 offset:47104
    ds_read_b64_tr_b16 v[78:79], v17 offset:47616
    ds_read_b64_tr_b16 v[80:81], v18 offset:47104
    ds_read_b64_tr_b16 v[82:83], v18 offset:47616
    v_mfma_f32_32x32x16_bf16 v[36:51], v[64:67], v[104:107], v[36:51]
    buffer_load_dwordx4 v[88:91], v1, s[44:47], s53 offen offset:1024 sc1
    s_waitcnt vmcnt(11) lgkmcnt(4)
    v_mfma_f32_32x32x16_bf16 v[20:35], v[68:71], v[108:111], v[20:35]
    ds_read_b64_tr_b16 v[52:53], v17 offset:49152
    ds_read_b64_tr_b16 v[54:55], v17 offset:49664
    ds_read_b64_tr_b16 v[56:57], v18 offset:49152
    ds_read_b64_tr_b16 v[58:59], v18 offset:49664
    v_mfma_f32_32x32x16_bf16 v[36:51], v[72:75], v[108:111], v[36:51]
    buffer_load_dwordx4 v[92:95], v1, s[44:47], s53 offen offset:2048 sc1
    s_waitcnt vmcnt(11) lgkmcnt(4)
    v_mfma_f32_32x32x16_bf16 v[20:35], v[76:79], v[112:115], v[20:35]
    ds_read_b64_tr_b16 v[60:61], v17 offset:51200
    ds_read_b64_tr_b16 v[62:63], v17 offset:51712
    ds_read_b64_tr_b16 v[64:65], v18 offset:51200
    ds_read_b64_tr_b16 v[66:67], v18 offset:51712
    v_mfma_f32_32x32x16_bf16 v[36:51], v[80:83], v[112:115], v[36:51]
    buffer_load_dwordx4 v[96:99], v1, s[44:47], s53 offen offset:3072 sc1
    s_add_u32 s53, s53, 4096
    s_waitcnt vmcnt(11) lgkmcnt(4)
    v_mfma_f32_32x32x16_bf16 v[20:35], v[52:55], v[116:119], v[20:35]
    ds_read_b64_tr_b16 v[68:69], v17 offset:53248
    ds_read_b64_tr_b16 v[70:71], v17 offset:53760
    ds_read_b64_tr_b16 v[72:73], v18 offset:53248
    ds_read_b64_tr_b16 v[74:75], v18 offset:53760
    v_mfma_f32_32x32x16_bf16 v[36:51], v[56:59], v[116:119], v[36:51]
    buffer_load_dwordx4 v[100:103], v1, s[44:47], s53 offen offset:0 sc1
    s_waitcnt vmcnt(11) lgkmcnt(4)
    v_mfma_f32_32x32x16_bf16 v[20:35], v[60:63], v[120:123], v[20:35]
    ds_read_b64_tr_b16 v[76:77], v17 offset:55296
    ds_read_b64_tr_b16 v[78:79], v17 offset:55808
    ds_read_b64_tr_b16 v[80:81], v18 offset:55296
    ds_read_b64_tr_b16 v[82:83], v18 offset:55808
    v_mfma_f32_32x32x16_bf16 v[36:51], v[64:67], v[120:123], v[36:51]
    buffer_load_dwordx4 v[104:107], v1, s[44:47], s53 offen offset:1024 sc1
    s_waitcnt vmcnt(11) lgkmcnt(4)
    v_mfma_f32_32x32x16_bf16 v[20:35], v[68:71], v[124:127], v[20:35]
    ds_read_b64_tr_b16 v[52:53], v17 offset:57344
    ds_read_b64_tr_b16 v[54:55], v17 offset:57856
    ds_read_b64_tr_b16 v[56:57], v18 offset:57344
    ds_read_b64_tr_b16 v[58:59], v18 offset:57856
    v_mfma_f32_32x32x16_bf16 v[36:51], v[72:75], v[124:127], v[36:51]
    buffer_load_dwordx4 v[108:111], v1, s[44:47], s53 offen offset:2048 sc1
    s_waitcnt vmcnt(11) lgkmcnt(4)
    v_mfma_f32_32x32x16_bf16 v[20:35], v[76:79], v[128:131], v[20:35]
    ds_read_b64_tr_b16 v[60:61], v17 offset:59392
    ds_read_b64_tr_b16 v[62:63], v17 offset:59904
    ds_read_b64_tr_b16 v[64:65], v18 offset:59392
    ds_read_b64_tr_b16 v[66:67], v18 offset:59904
    v_mfma_f32_32x32x16_bf16 v[36:51], v[80:83], v[128:131], v[36:51]
    buffer_load_dwordx4 v[112:115], v1, s[44:47], s53 offen offset:3072 sc1
    s_waitcnt vmcnt(11) lgkmcnt(4)
    v_mfma_f32_32x32x16_bf16 v[20:35], v[52:55], v[132:135], v[20:35]
    ds_read_b64_tr_b16 v[68:69], v17 offset:61440
    ds_read_b64_tr_b16 v[70:71], v17 offset:61952
    ds_read_b64_tr_b16 v[72:73], v18 offset:61440
    ds_read_b64_tr_b16 v[74:75], v18 offset:61952
    v_mfma_f32_32x32x16_bf16 v[36:51], v[56:59], v[132:135], v[36:51]
    s_waitcnt vmcnt(10) lgkmcnt(4)
    v_mfma_f32_32x32x16_bf16 v[20:35], v[60:63], v[136:139], v[20:35]
    ds_read_b64_tr_b16 v[76:77], v17 offset:63488
    ds_read_b64_tr_b16 v[78:79], v17 offset:64000
    ds_read_b64_tr_b16 v[80:81], v18 offset:63488
    ds_read_b64_tr_b16 v[82:83], v18 offset:64000
    v_mfma_f32_32x32x16_bf16 v[36:51], v[64:67], v[136:139], v[36:51]
    s_waitcnt vmcnt(9) lgkmcnt(4)
    v_mfma_f32_32x32x16_bf16 v[20:35], v[68:71], v[140:143], v[20:35]
    v_add_u32 v17, 0x10000, v17
    v_add_u32 v18, 0x10000, v18
    ds_read_b64_tr_b16 v[52:53], v17 offset:0
    ds_read_b64_tr_b16 v[54:55], v17 offset:512
    ds_read_b64_tr_b16 v[56:57], v18 offset:0
    ds_read_b64_tr_b16 v[58:59], v18 offset:512
    v_mfma_f32_32x32x16_bf16 v[36:51], v[72:75], v[140:143], v[36:51]
    s_waitcnt vmcnt(8) lgkmcnt(4)
    v_mfma_f32_32x32x16_bf16 v[20:35], v[76:79], v[144:147], v[20:35]
    ds_read_b64_tr_b16 v[60:61], v17 offset:2048
    ds_read_b64_tr_b16 v[62:63], v17 offset:2560
    ds_read_b64_tr_b16 v[64:65], v18 offset:2048
    ds_read_b64_tr_b16 v[66:67], v18 offset:2560
    v_mfma_f32_32x32x16_bf16 v[36:51], v[80:83], v[144:147], v[36:51]
    s_waitcnt vmcnt(7) lgkmcnt(4)
    v_mfma_f32_32x32x16_bf16 v[20:35], v[52:55], v[84:87], v[20:35]
    ds_read_b64_tr_b16 v[68:69], v17 offset:4096
    ds_read_b64_tr_b16 v[70:71], v17 offset:4608
    ds_read_b64_tr_b16 v[72:73], v18 offset:4096
    ds_read_b64_tr_b16 v[74:75], v18 offset:4608
    v_mfma_f32_32x32x16_bf16 v[36:51], v[56:59], v[84:87], v[36:51]
    s_waitcnt vmcnt(6) lgkmcnt(4)
    v_mfma_f32_32x32x16_bf16 v[20:35], v[60:63], v[88:91], v[20:35]
    ds_read_b64_tr_b16 v[76:77], v17 offset:6144
    ds_read_b64_tr_b16 v[78:79], v17 offset:6656
    ds_read_b64_tr_b16 v[80:81], v18 offset:6144
    ds_read_b64_tr_b16 v[82:83], v18 offset:6656
    v_mfma_f32_32x32x16_bf16 v[36:51], v[64:67], v[88:91], v[36:51]
    s_waitcnt vmcnt(5) lgkmcnt(4)
    v_mfma_f32_32x32x16_bf16 v[20:35], v[68:71], v[92:95], v[20:35]
    ds_read_b64_tr_b16 v[52:53], v17 offset:8192
    ds_read_b64_tr_b16 v[54:55], v17 offset:8704
    ds_read_b64_tr_b16 v[56:57], v18 offset:8192
    ds_read_b64_tr_b16 v[58:59], v18 offset:8704
    v_mfma_f32_32x32x16_bf16 v[36:51], v[72:75], v[92:95], v[36:51]
    s_waitcnt vmcnt(4) lgkmcnt(4)
    v_mfma_f32_32x32x16_bf16 v[20:35], v[76:79], v[96:99], v[20:35]
    ds_read_b64_tr_b16 v[60:61], v17 offset:10240
    ds_read_b64_tr_b16 v[62:63], v17 offset:10752
    ds_read_b64_tr_b16 v[64:65], v18 offset:10240
    ds_read_b64_tr_b16 v[66:67], v18 offset:10752
    v_mfma_f32_32x32x16_bf16 v[36:51], v[80:83], v[96:99], v[36:51]
    s_waitcnt vmcnt(3) lgkmcnt(4)
    v_mfma_f32_32x32x16_bf16 v[20:35], v[52:55], v[100:103], v[20:35]
    ds_read_b64_tr_b16 v[68:69], v17 offset:12288
    ds_read_b64_tr_b16 v[70:71], v17 offset:12800
    ds_read_b64_tr_b16 v[72:73], v18 offset:12288
    ds_read_b64_tr_b16 v[74:75], v18 offset:12800
    v_mfma_f32_32x32x16_bf16 v[36:51], v[56:59], v[100:103], v[36:51]
    s_waitcnt vmcnt(2) lgkmcnt(4)
    v_mfma_f32_32x32x16_bf16 v[20:35], v[60:63], v[104:107], v[20:35]
    ds_read_b64_tr_b16 v[76:77], v17 offset:14336
    ds_read_b64_tr_b16 v[78:79], v17 offset:14848
    ds_read_b64_tr_b16 v[80:81], v18 offset:14336
    ds_read_b64_tr_b16 v[82:83], v18 offset:14848
    v_mfma_f32_32x32x16_bf16 v[36:51], v[64:67], v[104:107], v[36:51]
    s_waitcnt vmcnt(1) lgkmcnt(4)
    v_mfma_f32_32x32x16_bf16 v[20:35], v[68:71], v[108:111], v[20:35]
    v_mfma_f32_32x32x16_bf16 v[36:51], v[72:75], v[108:111], v[36:51]
    s_waitcnt vmcnt(0) lgkmcnt(0)
    v_mfma_f32_32x32x16_bf16 v[20:35], v[76:79], v[112:115], v[20:35]
    v_mfma_f32_32x32x16_bf16 v[36:51], v[80:83], v[112:115], v[36:51]
    s_mul_i32 s53, s49, 221184
    s_lshl_b32 s52, s11, 12
    s_add_u32 s53, s53, s52
    s_add_u32 s53, s53, 1310720
    s_nop 7
    v_cvt_pk_bf16_f32 v52, v20, v21
    v_cvt_pk_bf16_f32 v53, v22, v23
    v_cvt_pk_bf16_f32 v54, v24, v25
    v_cvt_pk_bf16_f32 v55, v26, v27
    buffer_store_dwordx4 v[52:55], v1, s[44:47], s53 offen offset:0 sc1
    v_cvt_pk_bf16_f32 v56, v28, v29
    v_cvt_pk_bf16_f32 v57, v30, v31
    v_cvt_pk_bf16_f32 v58, v32, v33
    v_cvt_pk_bf16_f32 v59, v34, v35
    buffer_store_dwordx4 v[56:59], v1, s[44:47], s53 offen offset:1024 sc1
    s_nop 1
    v_cvt_pk_bf16_f32 v60, v36, v37
    v_cvt_pk_bf16_f32 v61, v38, v39
    v_cvt_pk_bf16_f32 v62, v40, v41
    v_cvt_pk_bf16_f32 v63, v42, v43
    buffer_store_dwordx4 v[60:63], v1, s[44:47], s53 offen offset:2048 sc1
    v_cvt_pk_bf16_f32 v64, v44, v45
    v_cvt_pk_bf16_f32 v65, v46, v47
    v_cvt_pk_bf16_f32 v66, v48, v49
    v_cvt_pk_bf16_f32 v67, v50, v51
    buffer_store_dwordx4 v[64:67], v1, s[44:47], s53 offen offset:3072 sc1
    s_barrier
    s_lshr_b32 s50, s3, 1
    s_mul_i32 s53, s10, 221184
    s_mul_i32 s52, s50, 36864
    s_add_u32 s53, s53, s52
    s_add_u32 s53, s53, 1458176
    s_mul_i32 s52, s50, 73728
    v_add_u32 v17, s52, v3
    v_add_u32 v18, s52, v4
    v_min_u32 v9, 8, v0
    v_lshlrev_b32 v9, 7, v9
    s_mul_i32 s55, s10, 6912
    s_mul_i32 s52, s50, 1152
    s_add_u32 s55, s55, s52
    s_add_u32 s55, s55, 7606784
    s_waitcnt vmcnt(0)
    v_mov_b32 v12, 0
    s_mov_b64 exec, 1
    buffer_store_dword v13, v12, s[44:47], s54 offen sc1
    s_mov_b64 exec, -1
    s_barrier
    s_cmp_ge_u32 s6, 18
    s_cbranch_scc1 L_c_notu
    buffer_load_dwordx4 v[236:239], v235, s[32:35], s14 offen
L_gp_7:
    buffer_load_dword v10, v9, s[44:47], s55 offen sc1
    s_waitcnt vmcnt(0)
    v_cmp_ne_u32 vcc, s4, v10
    s_cbranch_vccz L_gpd_8
    s_sleep 2
    s_sub_u32 s7, s7, 1
    s_cmp_lg_u32 s7, 0
    s_cbranch_scc1 L_gp_7
    s_mov_b32 s7, 1
L_gpd_8:
    buffer_load_dwordx4 v[84:87], v2, s[44:47], s53 offen offset:0 sc1
    buffer_load_dwordx4 v[88:91], v2, s[44:47], s53 offen offset:1024 sc1
    buffer_load_dwordx4 v[92:95], v2, s[44:47], s53 offen offset:2048 sc1
    buffer_load_dwordx4 v[96:99], v2, s[44:47], s53 offen offset:3072 sc1
    s_add_u32 s53, s53, 4096
    buffer_load_dwordx4 v[100:103], v2, s[44:47], s53 offen offset:0 sc1
    buffer_load_dwordx4 v[104:107], v2, s[44:47], s53 offen offset:1024 sc1
    buffer_load_dwordx4 v[108:111], v2, s[44:47], s53 offen offset:2048 sc1
    buffer_load_dwordx4 v[112:115], v2, s[44:47], s53 offen offset:3072 sc1
    s_add_u32 s53, s53, 4096
    buffer_load_dwordx4 v[116:119], v2, s[44:47], s53 offen offset:0 sc1
    buffer_load_dwordx4 v[120:123], v2, s[44:47], s53 offen offset:1024 sc1
    buffer_load_dwordx4 v[124:127], v2, s[44:47], s53 offen offset:2048 sc1
    buffer_load_dwordx4 v[128:131], v2, s[44:47], s53 offen offset:3072 sc1
    s_add_u32 s53, s53, 4096
    s_barrier
    ds_read_b64_tr_b16 v[52:53], v17 offset:0
    ds_read_b64_tr_b16 v[54:55], v17 offset:512
    ds_read_b64_tr_b16 v[56:57], v18 offset:0
    ds_read_b64_tr_b16 v[58:59], v18 offset:512
    ds_read_b64_tr_b16 v[60:61], v17 offset:2048
    ds_read_b64_tr_b16 v[62:63], v17 offset:2560
    ds_read_b64_tr_b16 v[64:65], v18 offset:2048
    ds_read_b64_tr_b16 v[66:67], v18 offset:2560
    s_waitcnt vmcnt(11) lgkmcnt(4)
    v_mfma_f32_32x32x16_bf16 v[20:35], v[84:87], v[52:55], 0
    ds_read_b64_tr_b16 v[68:69], v17 offset:4096
    ds_read_b64_tr_b16 v[70:71], v17 offset:4608
    ds_read_b64_tr_b16 v[72:73], v18 offset:4096
    ds_read_b64_tr_b16 v[74:75], v18 offset:4608
    v_mfma_f32_32x32x16_bf16 v[36:51], v[84:87], v[56:59], 0
    buffer_load_dwordx4 v[132:135], v2, s[44:47], s53 offen offset:0 sc1
    s_waitcnt vmcnt(11) lgkmcnt(4)
    v_mfma_f32_32x32x16_bf16 v[20:35], v[88:91], v[60:63], v[20:35]
    ds_read_b64_tr_b16 v[76:77], v17 offset:6144
    ds_read_b64_tr_b16 v[78:79], v17 offset:6656
    ds_read_b64_tr_b16 v[80:81], v18 offset:6144
    ds_read_b64_tr_b16 v[82:83], v18 offset:6656
    v_mfma_f32_32x32x16_bf16 v[36:51], v[88:91], v[64:67], v[36:51]
    buffer_load_dwordx4 v[136:139], v2, s[44:47], s53 offen offset:1024 sc1
    s_waitcnt vmcnt(11) lgkmcnt(4)
    v_mfma_f32_32x32x16_bf16 v[20:35], v[92:95], v[68:71], v[20:35]
    ds_read_b64_tr_b16 v[52:53], v17 offset:8192
    ds_read_b64_tr_b16 v[54:55], v17 offset:8704
    ds_read_b64_tr_b16 v[56:57], v18 offset:8192
    ds_read_b64_tr_b16 v[58:59], v18 offset:8704
    v_mfma_f32_32x32x16_bf16 v[36:51], v[92:95], v[72:75], v[36:51]
    buffer_load_dwordx4 v[140:143], v2, s[44:47], s53 offen offset:2048 sc1
    s_waitcnt vmcnt(11) lgkmcnt(4)
    v_mfma_f32_32x32x16_bf16 v[20:35], v[96:99], v[76:79], v[20:35]
    ds_read_b64_tr_b16 v[60:61], v17 offset:10240
    ds_read_b64_tr_b16 v[62:63], v17 offset:10752
    ds_read_b64_tr_b16 v[64:65], v18 offset:10240
    ds_read_b64_tr_b16 v[66:67], v18 offset:10752
    v_mfma_f32_32x32x16_bf16 v[36:51], v[96:99], v[80:83], v[36:51]
    buffer_load_dwordx4 v[144:147], v2, s[44:47], s53 offen offset:3072 sc1
    s_add_u32 s53, s53, 4096
    s_waitcnt vmcnt(11) lgkmcnt(4)
    v_mfma_f32_32x32x16_bf16 v[20:35], v[100:103], v[52:55], v[20:35]
    ds_read_b64_tr_b16 v[68:69], v17 offset:12288
    ds_read_b64_tr_b16 v[70:71], v17 offset:12800
    ds_read_b64_tr_b16 v[72:73], v18 offset:12288
    ds_read_b64_tr_b16 v[74:75], v18 offset:12800
    v_mfma_f32_32x32x16_bf16 v[36:51], v[100:103], v[56:59], v[36:51]
    buffer_load_dwordx4 v[84:87], v2, s[44:47], s53 offen offset:0 sc1
    s_waitcnt vmcnt(11) lgkmcnt(4)
    v_mfma_f32_32x32x16_bf16 v[20:35], v[104:107], v[60:63], v[20:35]
    ds_read_b64_tr_b16 v[76:77], v17 offset:14336
    ds_read_b64_tr_b16 v[78:79], v17 offset:14848
    ds_read_b64_tr_b16 v[80:81], v18 offset:14336
    ds_read_b64_tr_b16 v[82:83], v18 offset:14848
    v_mfma_f32_32x32x16_bf16 v[36:51], v[104:107], v[64:67], v[36:51]
    buffer_load_dwordx4 v[88:91], v2, s[44:47], s53 offen offset:1024 sc1
    s_waitcnt vmcnt(11) lgkmcnt(4)
    v_mfma_f32_32x32x16_bf16 v[20:35], v[108:111], v[68:71], v[20:35]
    ds_read_b64_tr_b16 v[52:53], v17 offset:16384
    ds_read_b64_tr_b16 v[54:55], v17 offset:16896
    ds_read_b64_tr_b16 v[56:57], v18 offset:16384
    ds_read_b64_tr_b16 v[58:59], v18 offset:16896
    v_mfma_f32_32x32x16_bf16 v[36:51], v[108:111], v[72:75], v[36:51]
    buffer_load_dwordx4 v[92:95], v2, s[44:47], s53 offen offset:2048 sc1
    s_waitcnt vmcnt(11) lgkmcnt(4)
    v_mfma_f32_32x32x16_bf16 v[20:35], v[112:115], v[76:79], v[20:35]
    ds_read_b64_tr_b16 v[60:61], v17 offset:18432
    ds_read_b64_tr_b16 v[62:63], v17 offset:18944
    ds_read_b64_tr_b16 v[64:65], v18 offset:18432
    ds_read_b64_tr_b16 v[66:67], v18 offset:18944
    v_mfma_f32_32x32x16_bf16 v[36:51], v[112:115], v[80:83], v[36:51]
    buffer_load_dwordx4 v[96:99], v2, s[44:47], s53 offen offset:3072 sc1
    s_add_u32 s53, s53, 4096
    s_waitcnt vmcnt(11) lgkmcnt(4)
    v_mfma_f32_32x32x16_bf16 v[20:35], v[116:119], v[52:55], v[20:35]
    ds_read_b64_tr_b16 v[68:69], v17 offset:20480
    ds_read_b64_tr_b16 v[70:71], v17 offset:20992
    ds_read_b64_tr_b16 v[72:73], v18 offset:20480
    ds_read_b64_tr_b16 v[74:75], v18 offset:20992
    v_mfma_f32_32x32x16_bf16 v[36:51], v[116:119], v[56:59], v[36:51]
    buffer_load_dwordx4 v[100:103], v2, s[44:47], s53 offen offset:0 sc1
    s_waitcnt vmcnt(11) lgkmcnt(4)
    v_mfma_f32_32x32x16_bf16 v[20:35], v[120:123], v[60:63], v[20:35]
    ds_read_b64_tr_b16 v[76:77], v17 offset:22528
    ds_read_b64_tr_b16 v[78:79], v17 offset:23040
    ds_read_b64_tr_b16 v[80:81], v18 offset:22528
    ds_read_b64_tr_b16 v[82:83], v18 offset:23040
    v_mfma_f32_32x32x16_bf16 v[36:51], v[120:123], v[64:67], v[36:51]
    buffer_load_dwordx4 v[104:107], v2, s[44:47], s53 offen offset:1024 sc1
    s_waitcnt vmcnt(11) lgkmcnt(4)
    v_mfma_f32_32x32x16_bf16 v[20:35], v[124:127], v[68:71], v[20:35]
    ds_read_b64_tr_b16 v[52:53], v17 offset:24576
    ds_read_b64_tr_b16 v[54:55], v17 offset:25088
    ds_read_b64_tr_b16 v[56:57], v18 offset:24576
    ds_read_b64_tr_b16 v[58:59], v18 offset:25088
    v_mfma_f32_32x32x16_bf16 v[36:51], v[124:127], v[72:75], v[36:51]
    buffer_load_dwordx4 v[108:111], v2, s[44:47], s53 offen offset:2048 sc1
    s_waitcnt vmcnt(11) lgkmcnt(4)
    v_mfma_f32_32x32x16_bf16 v[20:35], v[128:131], v[76:79], v[20:35]
    ds_read_b64_tr_b16 v[60:61], v17 offset:26624
    ds_read_b64_tr_b16 v[62:63], v17 offset:27136
    ds_read_b64_tr_b16 v[64:65], v18 offset:26624
    ds_read_b64_tr_b16 v[66:67], v18 offset:27136
    v_mfma_f32_32x32x16_bf16 v[36:51], v[128:131], v[80:83], v[36:51]
    buffer_load_dwordx4 v[112:115], v2, s[44:47], s53 offen offset:3072 sc1
    s_add_u32 s53, s53, 4096
    s_waitcnt vmcnt(11) lgkmcnt(4)
    v_mfma_f32_32x32x16_bf16 v[20:35], v[132:135], v[52:55], v[20:35]
    ds_read_b64_tr_b16 v[68:69], v17 offset:28672
    ds_read_b64_tr_b16 v[70:71], v17 offset:29184
    ds_read_b64_tr_b16 v[72:73], v18 offset:28672
    ds_read_b64_tr_b16 v[74:75], v18 offset:29184
    v_mfma_f32_32x32x16_bf16 v[36:51], v[132:135], v[56:59], v[36:51]
    buffer_load_dwordx4 v[116:119], v2, s[44:47], s53 offen offset:0 sc1
    s_waitcnt vmcnt(11) lgkmcnt(4)
    v_mfma_f32_32x32x16_bf16 v[20:35], v[136:139], v[60:63], v[20:35]
    ds_read_b64_tr_b16 v[76:77], v17 offset:30720
    ds_read_b64_tr_b16 v[78:79], v17 offset:31232
    ds_read_b64_tr_b16 v[80:81], v18 offset:30720
    ds_read_b64_tr_b16 v[82:83], v18 offset:31232
    v_mfma_f32_32x32x16_bf16 v[36:51], v[136:139], v[64:67], v[36:51]
    buffer_load_dwordx4 v[120:123], v2, s[44:47], s53 offen offset:1024 sc1
    s_waitcnt vmcnt(11) lgkmcnt(4)
    v_mfma_f32_32x32x16_bf16 v[20:35], v[140:143], v[68:71], v[20:35]
    ds_read_b64_tr_b16 v[52:53], v17 offset:32768
    ds_read_b64_tr_b16 v[54:55], v17 offset:33280
    ds_read_b64_tr_b16 v[56:57], v18 offset:32768
    ds_read_b64_tr_b16 v[58:59], v18 offset:33280
    v_mfma_f32_32x32x16_bf16 v[36:51], v[140:143], v[72:75], v[36:51]
    buffer_load_dwordx4 v[124:127], v2, s[44:47], s53 offen offset:2048 sc1
    s_waitcnt vmcnt(11) lgkmcnt(4)
    v_mfma_f32_32x32x16_bf16 v[20:35], v[144:147], v[76:79], v[20:35]
    ds_read_b64_tr_b16 v[60:61], v17 offset:34816
    ds_read_b64_tr_b16 v[62:63], v17 offset:35328
    ds_read_b64_tr_b16 v[64:65], v18 offset:34816
    ds_read_b64_tr_b16 v[66:67], v18 offset:35328
    v_mfma_f32_32x32x16_bf16 v[36:51], v[144:147], v[80:83], v[36:51]
    buffer_load_dwordx4 v[128:131], v2, s[44:47], s53 offen offset:3072 sc1
    s_add_u32 s53, s53, 4096
    s_waitcnt vmcnt(11) lgkmcnt(4)
    v_mfma_f32_32x32x16_bf16 v[20:35], v[84:87], v[52:55], v[20:35]
    ds_read_b64_tr_b16 v[68:69], v17 offset:36864
    ds_read_b64_tr_b16 v[70:71], v17 offset:37376
    ds_read_b64_tr_b16 v[72:73], v18 offset:36864
    ds_read_b64_tr_b16 v[74:75], v18 offset:37376
    v_mfma_f32_32x32x16_bf16 v[36:51], v[84:87], v[56:59], v[36:51]
    buffer_load_dwordx4 v[132:135], v2, s[44:47], s53 offen offset:0 sc1
    s_waitcnt vmcnt(11) lgkmcnt(4)
    v_mfma_f32_32x32x16_bf16 v[20:35], v[88:91], v[60:63], v[20:35]
    ds_read_b64_tr_b16 v[76:77], v17 offset:38912
    ds_read_b64_tr_b16 v[78:79], v17 offset:39424
    ds_read_b64_tr_b16 v[80:81], v18 offset:38912
    ds_read_b64_tr_b16 v[82:83], v18 offset:39424
    v_mfma_f32_32x32x16_bf16 v[36:51], v[88:91], v[64:67], v[36:51]
    buffer_load_dwordx4 v[136:139], v2, s[44:47], s53 offen offset:1024 sc1
    s_waitcnt vmcnt(11) lgkmcnt(4)
    v_mfma_f32_32x32x16_bf16 v[20:35], v[92:95], v[68:71], v[20:35]
    ds_read_b64_tr_b16 v[52:53], v17 offset:40960
    ds_read_b64_tr_b16 v[54:55], v17 offset:41472
    ds_read_b64_tr_b16 v[56:57], v18 offset:40960
    ds_read_b64_tr_b16 v[58:59], v18 offset:41472
    v_mfma_f32_32x32x16_bf16 v[36:51], v[92:95], v[72:75], v[36:51]
    buffer_load_dwordx4 v[140:143], v2, s[44:47], s53 offen offset:2048 sc1
    s_waitcnt vmcnt(11) lgkmcnt(4)
    v_mfma_f32_32x32x16_bf16 v[20:35], v[96:99], v[76:79], v[20:35]
    ds_read_b64_tr_b16 v[60:61], v17 offset:43008
    ds_read_b64_tr_b16 v[62:63], v17 offset:43520
    ds_read_b64_tr_b16 v[64:65], v18 offset:43008
    ds_read_b64_tr_b16 v[66:67], v18 offset:43520
    v_mfma_f32_32x32x16_bf16 v[36:51], v[96:99], v[80:83], v[36:51]
    buffer_load_dwordx4 v[144:147], v2, s[44:47], s53 offen offset:3072 sc1
    s_add_u32 s53, s53, 4096
    s_waitcnt vmcnt(11) lgkmcnt(4)
    v_mfma_f32_32x32x16_bf16 v[20:35], v[100:103], v[52:55], v[20:35]
    ds_read_b64_tr_b16 v[68:69], v17 offset:45056
    ds_read_b64_tr_b16 v[70:71], v17 offset:45568
    ds_read_b64_tr_b16 v[72:73], v18 offset:45056
    ds_read_b64_tr_b16 v[74:75], v18 offset:45568
    v_mfma_f32_32x32x16_bf16 v[36:51], v[100:103], v[56:59], v[36:51]
    buffer_load_dwordx4 v[84:87], v2, s[44:47], s53 offen offset:0 sc1
    s_waitcnt vmcnt(11) lgkmcnt(4)
    v_mfma_f32_32x32x16_bf16 v[20:35], v[104:107], v[60:63], v[20:35]
    ds_read_b64_tr_b16 v[76:77], v17 offset:47104
    ds_read_b64_tr_b16 v[78:79], v17 offset:47616
    ds_read_b64_tr_b16 v[80:81], v18 offset:47104
    ds_read_b64_tr_b16 v[82:83], v18 offset:47616
    v_mfma_f32_32x32x16_bf16 v[36:51], v[104:107], v[64:67], v[36:51]
    buffer_load_dwordx4 v[88:91], v2, s[44:47], s53 offen offset:1024 sc1
    s_waitcnt vmcnt(11) lgkmcnt(4)
    v_mfma_f32_32x32x16_bf16 v[20:35], v[108:111], v[68:71], v[20:35]
    ds_read_b64_tr_b16 v[52:53], v17 offset:49152
    ds_read_b64_tr_b16 v[54:55], v17 offset:49664
    ds_read_b64_tr_b16 v[56:57], v18 offset:49152
    ds_read_b64_tr_b16 v[58:59], v18 offset:49664
    v_mfma_f32_32x32x16_bf16 v[36:51], v[108:111], v[72:75], v[36:51]
    buffer_load_dwordx4 v[92:95], v2, s[44:47], s53 offen offset:2048 sc1
    s_waitcnt vmcnt(11) lgkmcnt(4)
    v_mfma_f32_32x32x16_bf16 v[20:35], v[112:115], v[76:79], v[20:35]
    ds_read_b64_tr_b16 v[60:61], v17 offset:51200
    ds_read_b64_tr_b16 v[62:63], v17 offset:51712
    ds_read_b64_tr_b16 v[64:65], v18 offset:51200
    ds_read_b64_tr_b16 v[66:67], v18 offset:51712
    v_mfma_f32_32x32x16_bf16 v[36:51], v[112:115], v[80:83], v[36:51]
    buffer_load_dwordx4 v[96:99], v2, s[44:47], s53 offen offset:3072 sc1
    s_waitcnt vmcnt(11) lgkmcnt(4)
    v_mfma_f32_32x32x16_bf16 v[20:35], v[116:119], v[52:55], v[20:35]
    ds_read_b64_tr_b16 v[68:69], v17 offset:53248
    ds_read_b64_tr_b16 v[70:71], v17 offset:53760
    ds_read_b64_tr_b16 v[72:73], v18 offset:53248
    ds_read_b64_tr_b16 v[74:75], v18 offset:53760
    v_mfma_f32_32x32x16_bf16 v[36:51], v[116:119], v[56:59], v[36:51]
    s_waitcnt vmcnt(10) lgkmcnt(4)
    v_mfma_f32_32x32x16_bf16 v[20:35], v[120:123], v[60:63], v[20:35]
    ds_read_b64_tr_b16 v[76:77], v17 offset:55296
    ds_read_b64_tr_b16 v[78:79], v17 offset:55808
    ds_read_b64_tr_b16 v[80:81], v18 offset:55296
    ds_read_b64_tr_b16 v[82:83], v18 offset:55808
    v_mfma_f32_32x32x16_bf16 v[36:51], v[120:123], v[64:67], v[36:51]
    s_waitcnt vmcnt(9) lgkmcnt(4)
    v_mfma_f32_32x32x16_bf16 v[20:35], v[124:127], v[68:71], v[20:35]
    ds_read_b64_tr_b16 v[52:53], v17 offset:57344
    ds_read_b64_tr_b16 v[54:55], v17 offset:57856
    ds_read_b64_tr_b16 v[56:57], v18 offset:57344
    ds_read_b64_tr_b16 v[58:59], v18 offset:57856
    v_mfma_f32_32x32x16_bf16 v[36:51], v[124:127], v[72:75], v[36:51]
    s_waitcnt vmcnt(8) lgkmcnt(4)
    v_mfma_f32_32x32x16_bf16 v[20:35], v[128:131], v[76:79], v[20:35]
    ds_read_b64_tr_b16 v[60:61], v17 offset:59392
    ds_read_b64_tr_b16 v[62:63], v17 offset:59904
    ds_read_b64_tr_b16 v[64:65], v18 offset:59392
    ds_read_b64_tr_b16 v[66:67], v18 offset:59904
    v_mfma_f32_32x32x16_bf16 v[36:51], v[128:131], v[80:83], v[36:51]
    s_waitcnt vmcnt(7) lgkmcnt(4)
    v_mfma_f32_32x32x16_bf16 v[20:35], v[132:135], v[52:55], v[20:35]
    ds_read_b64_tr_b16 v[68:69], v17 offset:61440
    ds_read_b64_tr_b16 v[70:71], v17 offset:61952
    ds_read_b64_tr_b16 v[72:73], v18 offset:61440
    ds_read_b64_tr_b16 v[74:75], v18 offset:61952
    v_mfma_f32_32x32x16_bf16 v[36:51], v[132:135], v[56:59], v[36:51]
    s_waitcnt vmcnt(6) lgkmcnt(4)
    v_mfma_f32_32x32x16_bf16 v[20:35], v[136:139], v[60:63], v[20:35]
    ds_read_b64_tr_b16 v[76:77], v17 offset:63488
    ds_read_b64_tr_b16 v[78:79], v17 offset:64000
    ds_read_b64_tr_b16 v[80:81], v18 offset:63488
    ds_read_b64_tr_b16 v[82:83], v18 offset:64000
    v_mfma_f32_32x32x16_bf16 v[36:51], v[136:139], v[64:67], v[36:51]
    s_waitcnt vmcnt(5) lgkmcnt(4)
    v_mfma_f32_32x32x16_bf16 v[20:35], v[140:143], v[68:71], v[20:35]
    v_add_u32 v17, 0x10000, v17
    v_add_u32 v18, 0x10000, v18
    ds_read_b64_tr_b16 v[52:53], v17 offset:0
    ds_read_b64_tr_b16 v[54:55], v17 offset:512
    ds_read_b64_tr_b16 v[56:57], v18 offset:0
    ds_read_b64_tr_b16 v[58:59], v18 offset:512
    v_mfma_f32_32x32x16_bf16 v[36:51], v[140:143], v[72:75], v[36:51]
    s_waitcnt vmcnt(4) lgkmcnt(4)
    v_mfma_f32_32x32x16_bf16 v[20:35], v[144:147], v[76:79], v[20:35]
    ds_read_b64_tr_b16 v[60:61], v17 offset:2048
    ds_read_b64_tr_b16 v[62:63], v17 offset:2560
    ds_read_b64_tr_b16 v[64:65], v18 offset:2048
    ds_read_b64_tr_b16 v[66:67], v18 offset:2560
    v_mfma_f32_32x32x16_bf16 v[36:51], v[144:147], v[80:83], v[36:51]
    s_waitcnt vmcnt(3) lgkmcnt(4)
    v_mfma_f32_32x32x16_bf16 v[20:35], v[84:87], v[52:55], v[20:35]
    ds_read_b64_tr_b16 v[68:69], v17 offset:4096
    ds_read_b64_tr_b16 v[70:71], v17 offset:4608
    ds_read_b64_tr_b16 v[72:73], v18 offset:4096
    ds_read_b64_tr_b16 v[74:75], v18 offset:4608
    v_mfma_f32_32x32x16_bf16 v[36:51], v[84:87], v[56:59], v[36:51]
    s_waitcnt vmcnt(2) lgkmcnt(4)
    v_mfma_f32_32x32x16_bf16 v[20:35], v[88:91], v[60:63], v[20:35]
    ds_read_b64_tr_b16 v[76:77], v17 offset:6144
    ds_read_b64_tr_b16 v[78:79], v17 offset:6656
    ds_read_b64_tr_b16 v[80:81], v18 offset:6144
    ds_read_b64_tr_b16 v[82:83], v18 offset:6656
    v_mfma_f32_32x32x16_bf16 v[36:51], v[88:91], v[64:67], v[36:51]
    s_waitcnt vmcnt(1) lgkmcnt(4)
    v_mfma_f32_32x32x16_bf16 v[20:35], v[92:95], v[68:71], v[20:35]
    v_mfma_f32_32x32x16_bf16 v[36:51], v[92:95], v[72:75], v[36:51]
    s_waitcnt vmcnt(0) lgkmcnt(0)
    v_mfma_f32_32x32x16_bf16 v[20:35], v[96:99], v[76:79], v[20:35]
    v_mfma_f32_32x32x16_bf16 v[36:51], v[96:99], v[80:83], v[36:51]
    s_lshl_b32 s52, s3, 12
    s_add_u32 s52, s52, 147456
    v_add_u32 v9, s52, v1
    v_xor_b32 v10, 8192, v9
    s_lshr_b32 s53, s10, 3
    s_mul_i32 s54, s53, 18
    s_add_u32 s54, s54, s9
    s_lshl_b32 s53, s54, 1
    s_add_u32 s53, s53, s50
    s_lshl_b32 s53, s53, 3
    s_and_b32 s52, s10, 7
    s_add_u32 s53, s53, s52
    s_lshl_b32 s54, s53, 7
    s_add_u32 s54, s54, 7733248
    s_lshl_b32 s53, s53, 11
    s_add_u32 s53, s53, 5570560
    s_cmp_lg_u32 s50, 0
    s_cbranch_scc1 L_kh1_9
    ds_write_b128 v9, v[36:39] offset:0
    ds_write_b128 v9, v[40:43] offset:1024
    ds_write_b128 v9, v[44:47] offset:2048
    ds_write_b128 v9, v[48:51] offset:3072
    s_branch L_j_10
L_kh1_9:
    ds_write_b128 v9, v[20:23] offset:0
    ds_write_b128 v9, v[24:27] offset:1024
    ds_write_b128 v9, v[28:31] offset:2048
    ds_write_b128 v9, v[32:35] offset:3072
    v_mov_b32 v20, v36
    v_mov_b32 v21, v37
    v_mov_b32 v22, v38
    v_mov_b32 v23, v39
    v_mov_b32 v24, v40
    v_mov_b32 v25, v41
    v_mov_b32 v26, v42
    v_mov_b32 v27, v43
    v_mov_b32 v28, v44
    v_mov_b32 v29, v45
    v_mov_b32 v30, v46
    v_mov_b32 v31, v47
    v_mov_b32 v32, v48
    v_mov_b32 v33, v49
    v_mov_b32 v34, v50
    v_mov_b32 v35, v51
L_j_10:
    s_waitcnt lgkmcnt(0)
    s_barrier
    ds_read_b128 v[52:55], v10 offset:0
    ds_read_b128 v[56:59], v10 offset:1024
    ds_read_b128 v[60:63], v10 offset:2048
    ds_read_b128 v[64:67], v10 offset:3072
    s_waitcnt lgkmcnt(2)
    v_add_f32 v20, v20, v52
    v_add_f32 v21, v21, v53
    v_add_f32 v22, v22, v54
    v_add_f32 v23, v23, v55
    v_add_f32 v24, v24, v56
    v_add_f32 v25, v25, v57
    v_add_f32 v26, v26, v58
    v_add_f32 v27, v27, v59
    v_cvt_pk_bf16_f32 v68, v20, v21
    v_cvt_pk_bf16_f32 v69, v22, v23
    v_cvt_pk_bf16_f32 v70, v24, v25
    v_cvt_pk_bf16_f32 v71, v26, v27
    buffer_store_dwordx4 v[68:71], v1, s[44:47], s53 offen offset:0 sc1
    s_waitcnt lgkmcnt(0)
    v_add_f32 v28, v28, v60
    v_add_f32 v29, v29, v61
    v_add_f32 v30, v30, v62
    v_add_f32 v31, v31, v63
    v_add_f32 v32, v32, v64
    v_add_f32 v33, v33, v65
    v_add_f32 v34, v34, v66
    v_add_f32 v35, v35, v67
    v_cvt_pk_bf16_f32 v72, v28, v29
    v_cvt_pk_bf16_f32 v73, v30, v31
    v_cvt_pk_bf16_f32 v74, v32, v33
    v_cvt_pk_bf16_f32 v75, v34, v35
    buffer_store_dwordx4 v[72:75], v1, s[44:47], s53 offen offset:1024 sc1
    s_waitcnt vmcnt(0)
    v_mov_b32 v12, 0
    s_mov_b64 exec, 1
    buffer_store_dword v13, v12, s[44:47], s54 offen sc1
    s_mov_b64 exec, -1
    s_barrier
    s_branch L_c_done
L_ld:
    s_cmp_ge_u32 s6, 18
    s_cbranch_scc1 L_ldnu_11
    s_sub_u32 s58, s3, 4
    s_lshl_b32 s59, s58, 10
    v_add_u32 v9, s59, v1
    s_bfe_u32 s60, s10, 0x10001
    s_mul_i32 s60, s60, 72
    s_bfe_u32 s59, s10, 0x10002
    s_mul_i32 s59, s59, 36
    s_add_u32 s60, s60, s59
    s_add_u32 s58, s58, s60
    s_lshl_b32 s60, s60, 10
    s_mul_i32 s59, s58, 18432
    buffer_load_dwordx4 v[20:23], v14, s[36:39], s59 offen
    s_add_u32 s58, s58, 4
    s_mul_i32 s59, s58, 18432
    buffer_load_dwordx4 v[24:27], v14, s[36:39], s59 offen
    s_add_u32 s58, s58, 4
    s_mul_i32 s59, s58, 18432
    buffer_load_dwordx4 v[28:31], v14, s[36:39], s59 offen
    s_add_u32 s58, s58, 4
    s_mul_i32 s59, s58, 18432
    buffer_load_dwordx4 v[32:35], v14, s[36:39], s59 offen
    s_add_u32 s58, s58, 4
    s_mul_i32 s59, s58, 18432
    buffer_load_dwordx4 v[36:39], v14, s[36:39], s59 offen
    s_add_u32 s58, s58, 4
    s_mul_i32 s59, s58, 18432
    buffer_load_dwordx4 v[40:43], v14, s[36:39], s59 offen
    s_add_u32 s58, s58, 4
    s_mul_i32 s59, s58, 18432
    buffer_load_dwordx4 v[44:47], v14, s[36:39], s59 offen
    s_add_u32 s58, s58, 4
    s_mul_i32 s59, s58, 18432
    buffer_load_dwordx4 v[48:51], v14, s[36:39], s59 offen
    s_add_u32 s58, s58, 4
    s_mul_i32 s59, s58, 18432
    buffer_load_dwordx4 v[52:55], v14, s[36:39], s59 offen
    s_add_u32 s58, s58, 4
    s_sub_u32 s59, s58, 144
    s_cmp_ge_u32 s58, 144
    s_cselect_b32 s58, s59, s58
    s_mul_i32 s59, s58, 18432
    buffer_load_dwordx4 v[56:59], v14, s[36:39], s59 offen
    s_add_u32 s58, s58, 4
    s_mul_i32 s59, s58, 18432
    buffer_load_dwordx4 v[60:63], v14, s[36:39], s59 offen
    s_add_u32 s58, s58, 4
    s_mul_i32 s59, s58, 18432
    buffer_load_dwordx4 v[64:67], v14, s[36:39], s59 offen
    s_add_u32 s58, s58, 4
    s_mul_i32 s59, s58, 18432
    buffer_load_dwordx4 v[68:71], v14, s[36:39], s59 offen
    s_add_u32 s58, s58, 4
    s_mul_i32 s59, s58, 18432
    buffer_load_dwordx4 v[72:75], v14, s[36:39], s59 offen
    s_add_u32 s58, s58, 4
    s_mul_i32 s59, s58, 18432
    buffer_load_dwordx4 v[76:79], v14, s[36:39], s59 offen
    s_add_u32 s58, s58, 4
    s_mul_i32 s59, s58, 18432
    buffer_load_dwordx4 v[80:83], v14, s[36:39], s59 offen
    s_add_u32 s58, s58, 4
    s_mul_i32 s59, s58, 18432
    buffer_load_dwordx4 v[84:87], v14, s[36:39], s59 offen
    s_add_u32 s58, s58, 4
    s_mul_i32 s59, s58, 18432
    buffer_load_dwordx4 v[88:91], v14, s[36:39], s59 offen
    s_add_u32 s58, s58, 4
    s_sub_u32 s59, s58, 144
    s_cmp_ge_u32 s58, 144
    s_cselect_b32 s58, s59, s58
    s_barrier
    s_waitcnt vmcnt(0)
    v_add_u32 v10, s60, v9
    s_add_u32 s60, s60, 36864
    s_cmp_ge_u32 s60, 147456
    s_cselect_b32 s60, 0, s60
    ds_write_b128 v10, v[20:23] offset:0
    ds_write_b128 v10, v[24:27] offset:4096
    ds_write_b128 v10, v[28:31] offset:8192
    ds_write_b128 v10, v[32:35] offset:12288
    ds_write_b128 v10, v[36:39] offset:16384
    ds_write_b128 v10, v[40:43] offset:20480
    ds_write_b128 v10, v[44:47] offset:24576
    ds_write_b128 v10, v[48:51] offset:28672
    ds_write_b128 v10, v[52:55] offset:32768
    v_add_u32 v10, s60, v9
    s_add_u32 s60, s60, 36864
    s_cmp_ge_u32 s60, 147456
    s_cselect_b32 s60, 0, s60
    ds_write_b128 v10, v[56:59] offset:0
    ds_write_b128 v10, v[60:63] offset:4096
    ds_write_b128 v10, v[64:67] offset:8192
    s_barrier
    ds_write_b128 v10, v[68:71] offset:12288
    ds_write_b128 v10, v[72:75] offset:16384
    ds_write_b128 v10, v[76:79] offset:20480
    ds_write_b128 v10, v[80:83] offset:24576
    ds_write_b128 v10, v[84:87] offset:28672
    ds_write_b128 v10, v[88:91] offset:32768
    s_lshl_b32 m0, s58, 10
    s_mul_i32 s59, s58, 18432
    buffer_load_dwordx4 v14, s[36:39], s59 offen lds
    s_add_u32 s58, s58, 4
    s_lshl_b32 m0, s58, 10
    s_mul_i32 s59, s58, 18432
    buffer_load_dwordx4 v14, s[36:39], s59 offen lds
    s_add_u32 s58, s58, 4
    s_lshl_b32 m0, s58, 10
    s_mul_i32 s59, s58, 18432
    buffer_load_dwordx4 v14, s[36:39], s59 offen lds
    s_add_u32 s58, s58, 4
    s_lshl_b32 m0, s58, 10
    s_mul_i32 s59, s58, 18432
    buffer_load_dwordx4 v14, s[36:39], s59 offen lds
    s_add_u32 s58, s58, 4
    s_lshl_b32 m0, s58, 10
    s_mul_i32 s59, s58, 18432
    buffer_load_dwordx4 v14, s[36:39], s59 offen lds
    s_add_u32 s58, s58, 4
    s_lshl_b32 m0, s58, 10
    s_mul_i32 s59, s58, 18432
    buffer_load_dwordx4 v14, s[36:39], s59 offen lds
    s_add_u32 s58, s58, 4
    s_lshl_b32 m0, s58, 10
    s_mul_i32 s59, s58, 18432
    buffer_load_dwordx4 v14, s[36:39], s59 offen lds
    s_add_u32 s58, s58, 4
    s_lshl_b32 m0, s58, 10
    s_mul_i32 s59, s58, 18432
    buffer_load_dwordx4 v14, s[36:39], s59 offen lds
    s_add_u32 s58, s58, 4
    s_lshl_b32 m0, s58, 10
    s_mul_i32 s59, s58, 18432
    buffer_load_dwordx4 v14, s[36:39], s59 offen lds
    s_add_u32 s58, s58, 4
    s_sub_u32 s59, s58, 144
    s_cmp_ge_u32 s58, 144
    s_cselect_b32 s58, s59, s58
    s_lshl_b32 m0, s58, 10
    s_mul_i32 s59, s58, 18432
    buffer_load_dwordx4 v14, s[36:39], s59 offen lds
    s_add_u32 s58, s58, 4
    s_lshl_b32 m0, s58, 10
    s_mul_i32 s59, s58, 18432
    buffer_load_dwordx4 v14, s[36:39], s59 offen lds
    s_add_u32 s58, s58, 4
    s_lshl_b32 m0, s58, 10
    s_mul_i32 s59, s58, 18432
    buffer_load_dwordx4 v14, s[36:39], s59 offen lds
    s_add_u32 s58, s58, 4
    s_lshl_b32 m0, s58, 10
    s_mul_i32 s59, s58, 18432
    buffer_load_dwordx4 v14, s[36:39], s59 offen lds
    s_add_u32 s58, s58, 4
    s_lshl_b32 m0, s58, 10
    s_mul_i32 s59, s58, 18432
    buffer_load_dwordx4 v14, s[36:39], s59 offen lds
    s_add_u32 s58, s58, 4
    s_lshl_b32 m0, s58, 10
    s_mul_i32 s59, s58, 18432
    buffer_load_dwordx4 v14, s[36:39], s59 offen lds
    s_add_u32 s58, s58, 4
    s_lshl_b32 m0, s58, 10
    s_mul_i32 s59, s58, 18432
    buffer_load_dwordx4 v14, s[36:39], s59 offen lds
    s_add_u32 s58, s58, 4
    s_lshl_b32 m0, s58, 10
    s_mul_i32 s59, s58, 18432
    buffer_load_dwordx4 v14, s[36:39], s59 offen lds
    s_add_u32 s58, s58, 4
    s_lshl_b32 m0, s58, 10
    s_mul_i32 s59, s58, 18432
    buffer_load_dwordx4 v14, s[36:39], s59 offen lds
    s_waitcnt vmcnt(0) lgkmcnt(0)
    s_barrier
    buffer_load_dwordx4 v[236:239], v235, s[32:35], s14 offen
    s_waitcnt vmcnt(0)
    s_cmp_lg_u32 s3, 4
    s_cbranch_scc1 L_g4_12
    s_and_b32 s52, s5, 3
    s_mul_i32 s52, s52, 18
    s_min_u32 s54, s6, 17
    s_add_u32 s52, s52, s54
    s_lshr_b32 s49, s52, 3
    s_and_b32 s54, s52, 7
    s_lshr_b32 s56, s5, 2
    s_lshl_b32 s48, s56, 3
    s_add_u32 s48, s48, s54
    s_and_b32 s50, s3, 3
    s_lshr_b32 s51, s3, 2
    s_lshl_b32 s57, s49, 7
    s_lshl_b32 s53, s48, 3
    s_add_u32 s53, s53, s3
    s_mul_i32 s53, s53, 9216
    s_lshl_b32 s52, s57, 1
    s_add_u32 s53, s53, s52
    v_lshrrev_b32 v235, 4, v0
    v_mul_u32_u24 v235, 2304, v235
    v_and_b32 v12, 15, v0
    v_lshl_add_u32 v235, v12, 4, v235
    s_lshr_b32 s58, s57, 6
    s_lshl_b32 s58, s58, 7
    s_add_u32 s58, s58, 16384
    v_and_b32 v9, 1, v0
    v_lshlrev_b32 v9, 7, v9
    s_mul_i32 s59, s56, 4608
    s_lshl_b32 s60, s57, 2
    s_add_u32 s59, s59, s60
    s_add_u32 s59, s59, 81920
    v_lshlrev_b32 v11, 3, v0
L_gp_13:
    buffer_load_dword v10, v9, s[44:47], s58 offen sc1
    s_waitcnt vmcnt(0)
    v_cmp_ne_u32 vcc, s4, v10
    s_cbranch_vccz L_gpd_14
    s_sleep 2
    s_sub_u32 s7, s7, 1
    s_cmp_lg_u32 s7, 0
    s_cbranch_scc1 L_gp_13
    s_mov_b32 s7, 1
L_gpd_14:
    buffer_load_dwordx2 v[20:21], v11, s[44:47], s59 offen sc1
    s_waitcnt vmcnt(0)
    s_barrier
    ds_write_b64 v11, v[20:21] offset:36864
    s_waitcnt lgkmcnt(0)
    s_barrier
    s_branch L_c_done
L_g4_12:
    s_barrier
    s_barrier
    s_branch L_c_done
L_ldnu_11:
    s_barrier
    s_barrier
L_c_notu:
    s_sub_u32 s51, s6, 18
    s_lshr_b32 s57, s51, 2
    s_and_b32 s50, s3, 3
    s_and_b32 s48, s5, 1
    s_lshl_b32 s48, s48, 2
    s_and_b32 s52, s51, 3
    s_add_u32 s48, s48, s52
    s_and_b32 s49, s5, 2
    s_lshl_b32 s49, s49, 1
    s_lshr_b32 s52, s5, 2
    s_lshl_b32 s52, s52, 3
    s_add_u32 s48, s48, s52
    s_add_u32 s49, s49, s52
    s_min_u32 s60, s57, 1
    s_add_u32 s60, s60, s57
    s_mul_i32 s53, s49, 221184
    s_mul_i32 s54, s48, 221184
    s_mul_i32 s52, s50, 18432
    s_add_u32 s53, s53, s52
    s_add_u32 s54, s54, s52
    s_add_u32 s53, s53, 1384448
    s_add_u32 s54, s54, 1310720
    s_mul_i32 s52, s50, 18
    s_add_u32 s61, s52, 17
    s_lshr_b32 s52, s52, 2
    s_lshr_b32 s61, s61, 2
    v_and_b32 v9, 7, v0
    v_add_u32 v9, s52, v9
    v_min_u32 v9, s61, v9
    s_mul_i32 s52, s48, 54
    v_mov_b32 v10, s52
    s_add_u32 s52, s49, s60
    s_mul_i32 s52, s52, 54
    s_add_u32 s52, s52, 18
    v_mov_b32 v11, s52
    v_cmp_lt_u32 vcc, 7, v0
    s_mul_i32 s52, s49, 54
    s_add_u32 s52, s52, 72
    v_cndmask_b32 v10, v10, v11, vcc
    v_mov_b32 v11, s52
    v_cmp_lt_u32 vcc, 15, v0
    s_nop 1
    v_cndmask_b32 v10, v10, v11, vcc
    v_add_u32 v9, v9, v10
    v_lshlrev_b32 v9, 7, v9
    v_and_b32 v11, 0x2ff, v2
    v_and_b32 v10, 16, v0
    v_lshl_add_u32 v11, v10, 6, v11
    s_and_b32 s52, s57, 1
    s_lshl_b32 s52, s52, 8
    s_add_u32 s52, s52, 221184
    v_add_u32 v11, s52, v11
    s_mul_i32 s52, s60, 221184
    v_add_u32 v16, s52, v2
    s_mov_b32 s52, 7602176
    s_cmp_ge_u32 s3, 4
    s_cbranch_scc1 L_sidle_15
L_gp_16:
    buffer_load_dword v10, v9, s[44:47], s52 offen sc1
    s_waitcnt vmcnt(0)
    v_cmp_ne_u32 vcc, s4, v10
    s_cbranch_vccz L_gpd_17
    s_sleep 2
    s_sub_u32 s7, s7, 1
    s_cmp_lg_u32 s7, 0
    s_cbranch_scc1 L_gp_16
    s_mov_b32 s7, 1
L_gpd_17:
    buffer_load_dwordx4 v[72:75], v1, s[44:47], s54 offen offset:0 sc1
    buffer_load_dwordx4 v[76:79], v16, s[44:47], s53 offen offset:0 sc1
    buffer_load_dwordx4 v[80:83], v11, s[44:47], s53 offen offset:0 sc1
    buffer_load_dwordx4 v[84:87], v1, s[44:47], s54 offen offset:1024 sc1
    buffer_load_dwordx4 v[88:91], v16, s[44:47], s53 offen offset:1024 sc1
    buffer_load_dwordx4 v[92:95], v1, s[44:47], s54 offen offset:2048 sc1
    buffer_load_dwordx4 v[96:99], v16, s[44:47], s53 offen offset:2048 sc1
    buffer_load_dwordx4 v[100:103], v11, s[44:47], s53 offen offset:2048 sc1
    buffer_load_dwordx4 v[104:107], v1, s[44:47], s54 offen offset:3072 sc1
    buffer_load_dwordx4 v[108:111], v16, s[44:47], s53 offen offset:3072 sc1
    s_add_u32 s53, s53, 4096
    s_add_u32 s54, s54, 4096
    buffer_load_dwordx4 v[112:115], v1, s[44:47], s54 offen offset:0 sc1
    buffer_load_dwordx4 v[116:119], v16, s[44:47], s53 offen offset:0 sc1
    buffer_load_dwordx4 v[120:123], v11, s[44:47], s53 offen offset:0 sc1
    buffer_load_dwordx4 v[124:127], v1, s[44:47], s54 offen offset:1024 sc1
    buffer_load_dwordx4 v[128:131], v16, s[44:47], s53 offen offset:1024 sc1
    buffer_load_dwordx4 v[132:135], v1, s[44:47], s54 offen offset:2048 sc1
    buffer_load_dwordx4 v[136:139], v16, s[44:47], s53 offen offset:2048 sc1
    buffer_load_dwordx4 v[140:143], v11, s[44:47], s53 offen offset:2048 sc1
    buffer_load_dwordx4 v[144:147], v1, s[44:47], s54 offen offset:3072 sc1
    buffer_load_dwordx4 v[148:151], v16, s[44:47], s53 offen offset:3072 sc1
    s_add_u32 s53, s53, 4096
    s_add_u32 s54, s54, 4096
    s_waitcnt vmcnt(18)
    v_mfma_f32_32x32x16_bf16 v[20:35], v[76:79], v[72:75], 0
    s_waitcnt vmcnt(17)
    v_mfma_f32_32x32x16_bf16 v[36:51], v[80:83], v[72:75], 0
    s_waitcnt vmcnt(16)
    v_mfma_f32_32x32x16_bf16 v[56:71], v[80:83], v[84:87], 0
    s_waitcnt vmcnt(15)
    v_mfma_f32_32x32x16_bf16 v[20:35], v[88:91], v[84:87], v[20:35]
    buffer_load_dwordx4 v[152:155], v1, s[44:47], s54 offen offset:0 sc1
    buffer_load_dwordx4 v[156:159], v16, s[44:47], s53 offen offset:0 sc1
    buffer_load_dwordx4 v[160:163], v11, s[44:47], s53 offen offset:0 sc1
    buffer_load_dwordx4 v[164:167], v1, s[44:47], s54 offen offset:1024 sc1
    buffer_load_dwordx4 v[168:171], v16, s[44:47], s53 offen offset:1024 sc1
    s_waitcnt vmcnt(18)
    v_mfma_f32_32x32x16_bf16 v[20:35], v[96:99], v[92:95], v[20:35]
    s_waitcnt vmcnt(17)
    v_mfma_f32_32x32x16_bf16 v[36:51], v[100:103], v[92:95], v[36:51]
    s_waitcnt vmcnt(16)
    v_mfma_f32_32x32x16_bf16 v[56:71], v[100:103], v[104:107], v[56:71]
    s_waitcnt vmcnt(15)
    v_mfma_f32_32x32x16_bf16 v[20:35], v[108:111], v[104:107], v[20:35]
    buffer_load_dwordx4 v[172:175], v1, s[44:47], s54 offen offset:2048 sc1
    buffer_load_dwordx4 v[176:179], v16, s[44:47], s53 offen offset:2048 sc1
    buffer_load_dwordx4 v[180:183], v11, s[44:47], s53 offen offset:2048 sc1
    buffer_load_dwordx4 v[184:187], v1, s[44:47], s54 offen offset:3072 sc1
    buffer_load_dwordx4 v[188:191], v16, s[44:47], s53 offen offset:3072 sc1
    s_add_u32 s53, s53, 4096
    s_add_u32 s54, s54, 4096
    s_waitcnt vmcnt(18)
    v_mfma_f32_32x32x16_bf16 v[20:35], v[116:119], v[112:115], v[20:35]
    s_waitcnt vmcnt(17)
    v_mfma_f32_32x32x16_bf16 v[36:51], v[120:123], v[112:115], v[36:51]
    s_waitcnt vmcnt(16)
    v_mfma_f32_32x32x16_bf16 v[56:71], v[120:123], v[124:127], v[56:71]
    s_waitcnt vmcnt(15)
    v_mfma_f32_32x32x16_bf16 v[20:35], v[128:131], v[124:127], v[20:35]
    buffer_load_dwordx4 v[192:195], v1, s[44:47], s54 offen offset:0 sc1
    buffer_load_dwordx4 v[196:199], v16, s[44:47], s53 offen offset:0 sc1
    buffer_load_dwordx4 v[200:203], v11, s[44:47], s53 offen offset:0 sc1
    buffer_load_dwordx4 v[204:207], v1, s[44:47], s54 offen offset:1024 sc1
    buffer_load_dwordx4 v[208:211], v16, s[44:47], s53 offen offset:1024 sc1
    s_waitcnt vmcnt(18)
    v_mfma_f32_32x32x16_bf16 v[20:35], v[136:139], v[132:135], v[20:35]
    s_waitcnt vmcnt(17)
    v_mfma_f32_32x32x16_bf16 v[36:51], v[140:143], v[132:135], v[36:51]
    s_waitcnt vmcnt(16)
    v_mfma_f32_32x32x16_bf16 v[56:71], v[140:143], v[144:147], v[56:71]
    s_waitcnt vmcnt(15)
    v_mfma_f32_32x32x16_bf16 v[20:35], v[148:151], v[144:147], v[20:35]
    buffer_load_dwordx4 v[212:215], v1, s[44:47], s54 offen offset:2048 sc1
    buffer_load_dwordx4 v[216:219], v16, s[44:47], s53 offen offset:2048 sc1
    buffer_load_dwordx4 v[220:223], v11, s[44:47], s53 offen offset:2048 sc1
    buffer_load_dwordx4 v[224:227], v1, s[44:47], s54 offen offset:3072 sc1
    buffer_load_dwordx4 v[228:231], v16, s[44:47], s53 offen offset:3072 sc1
    s_add_u32 s53, s53, 4096
    s_add_u32 s54, s54, 4096
    s_waitcnt vmcnt(18)
    v_mfma_f32_32x32x16_bf16 v[20:35], v[156:159], v[152:155], v[20:35]
    s_waitcnt vmcnt(17)
    v_mfma_f32_32x32x16_bf16 v[36:51], v[160:163], v[152:155], v[36:51]
    s_waitcnt vmcnt(16)
    v_mfma_f32_32x32x16_bf16 v[56:71], v[160:163], v[164:167], v[56:71]
    s_waitcnt vmcnt(15)
    v_mfma_f32_32x32x16_bf16 v[20:35], v[168:171], v[164:167], v[20:35]
    buffer_load_dwordx4 v[72:75], v1, s[44:47], s54 offen offset:0 sc1
    buffer_load_dwordx4 v[76:79], v16, s[44:47], s53 offen offset:0 sc1
    buffer_load_dwordx4 v[80:83], v11, s[44:47], s53 offen offset:0 sc1
    buffer_load_dwordx4 v[84:87], v1, s[44:47], s54 offen offset:1024 sc1
    buffer_load_dwordx4 v[88:91], v16, s[44:47], s53 offen offset:1024 sc1
    s_waitcnt vmcnt(18)
    v_mfma_f32_32x32x16_bf16 v[20:35], v[176:179], v[172:175], v[20:35]
    s_waitcnt vmcnt(17)
    v_mfma_f32_32x32x16_bf16 v[36:51], v[180:183], v[172:175], v[36:51]
    s_waitcnt vmcnt(16)
    v_mfma_f32_32x32x16_bf16 v[56:71], v[180:183], v[184:187], v[56:71]
    s_waitcnt vmcnt(15)
    v_mfma_f32_32x32x16_bf16 v[20:35], v[188:191], v[184:187], v[20:35]
    s_waitcnt vmcnt(13)
    v_mfma_f32_32x32x16_bf16 v[20:35], v[196:199], v[192:195], v[20:35]
    s_waitcnt vmcnt(12)
    v_mfma_f32_32x32x16_bf16 v[36:51], v[200:203], v[192:195], v[36:51]
    s_waitcnt vmcnt(11)
    v_mfma_f32_32x32x16_bf16 v[56:71], v[200:203], v[204:207], v[56:71]
    s_waitcnt vmcnt(10)
    v_mfma_f32_32x32x16_bf16 v[20:35], v[208:211], v[204:207], v[20:35]
    s_waitcnt vmcnt(8)
    v_mfma_f32_32x32x16_bf16 v[20:35], v[216:219], v[212:215], v[20:35]
    s_waitcnt vmcnt(7)
    v_mfma_f32_32x32x16_bf16 v[36:51], v[220:223], v[212:215], v[36:51]
    s_waitcnt vmcnt(6)
    v_mfma_f32_32x32x16_bf16 v[56:71], v[220:223], v[224:227], v[56:71]
    s_waitcnt vmcnt(5)
    v_mfma_f32_32x32x16_bf16 v[20:35], v[228:231], v[224:227], v[20:35]
    s_waitcnt vmcnt(3)
    v_mfma_f32_32x32x16_bf16 v[20:35], v[76:79], v[72:75], v[20:35]
    s_waitcnt vmcnt(2)
    v_mfma_f32_32x32x16_bf16 v[36:51], v[80:83], v[72:75], v[36:51]
    s_waitcnt vmcnt(1)
    v_mfma_f32_32x32x16_bf16 v[56:71], v[80:83], v[84:87], v[56:71]
    s_waitcnt vmcnt(0)
    v_mfma_f32_32x32x16_bf16 v[20:35], v[88:91], v[84:87], v[20:35]
    s_mul_i32 s52, s3, 8448
    v_lshl_add_u32 v9, v7, 4, v1
    v_add_u32 v9, s52, v9
    s_nop 7
    v_add_f32 v36, v36, v64
    v_add_f32 v37, v37, v65
    v_add_f32 v38, v38, v66
    v_add_f32 v39, v39, v67
    v_add_f32 v40, v40, v68
    v_add_f32 v41, v41, v69
    v_add_f32 v42, v42, v70
    v_add_f32 v43, v43, v71
    ds_write_b128 v9, v[36:39] offset:4224
    ds_write_b128 v9, v[40:43] offset:5280
    ds_write_b128 v9, v[20:23] offset:0
    ds_write_b128 v9, v[24:27] offset:1056
    ds_write_b128 v9, v[28:31] offset:2112
    ds_write_b128 v9, v[32:35] offset:3168
L_sidle_15:
    v_bfe_u32 v10, v0, 2, 2
    v_and_b32 v11, 1, v0
    v_lshl_add_u32 v10, v10, 1, v11
    v_mul_u32_u24 v10, 1056, v10
    v_bfe_u32 v11, v0, 1, 1
    v_mul_u32_u24 v11, 528, v11
    v_lshrrev_b32 v9, 4, v0
    s_lshl_b32 s52, s3, 2
    v_add_u32 v9, s52, v9
    v_lshl_add_u32 v10, v9, 4, v10
    v_add_u32 v10, v10, v11
    v_and_b32 v11, 7, v0
    v_lshlrev_b32 v11, 4, v11
    v_lshl_add_u32 v11, v9, 10, v11
    s_lshl_b32 s52, s60, 7
    v_mov_b32 v9, s52
    v_and_b32 v12, 8, v0
    v_cmp_ne_u32 vcc, 0, v12
    s_and_b32 s52, s57, 1
    s_lshl_b32 s52, s52, 6
    s_add_u32 s52, s52, 128
    v_mov_b32 v12, s52
    s_lshl_b32 s51, s48, 15
    v_cndmask_b32 v9, v9, v12, vcc
    v_add_u32 v11, v11, v9
    s_and_b32 s52, s49, 7
    s_lshl_b32 s52, s52, 7
    s_add_u32 s51, s51, s52
    s_add_u32 s51, s51, 6815744
    s_lshl_b32 s53, s48, 3
    s_add_u32 s53, s53, s3
    s_mul_i32 s53, s53, 6
    s_bfe_u32 s52, s49, 0x10002
    s_mul_i32 s52, s52, 3
    s_add_u32 s53, s53, s52
    s_add_u32 s53, s53, s57
    s_lshl_b32 s53, s53, 7
    s_add_u32 s53, s53, 7471104
    s_mov_b32 s58, 0x0fff0fff
    s_cmp_eq_u32 s57, 2
    s_cselect_b32 s58, 0x00ff00ff, s58
    s_mov_b32 s59, s58
    v_mov_b32 v53, v13
    v_mov_b32 v55, v13
    s_waitcnt lgkmcnt(0)
    s_barrier
    ds_read_b128 v[20:23], v10 offset:0
    ds_read_b128 v[24:27], v10 offset:8448
    ds_read_b128 v[28:31], v10 offset:16896
    ds_read_b128 v[32:35], v10 offset:25344
    s_waitcnt lgkmcnt(2)
    v_add_f32 v20, v20, v24
    v_add_f32 v21, v21, v25
    v_add_f32 v22, v22, v26
    v_add_f32 v23, v23, v27
    s_waitcnt lgkmcnt(0)
    v_add_f32 v28, v28, v32
    v_add_f32 v29, v29, v33
    v_add_f32 v30, v30, v34
    v_add_f32 v31, v31, v35
    v_add_f32 v20, v20, v28
    v_add_f32 v21, v21, v29
    v_add_f32 v22, v22, v30
    v_add_f32 v23, v23, v31
    v_cvt_pk_bf16_f32 v52, v20, v21
    v_cvt_pk_bf16_f32 v54, v22, v23
    v_lshlrev_b32 v20, 16, v52
    v_and_b32 v21, 0xffff0000, v52
    v_lshlrev_b32 v22, 16, v54
    v_and_b32 v23, 0xffff0000, v54
    v_mul_f32 v20, 0x3cf15bef, v20
    v_mul_f32 v21, 0x3cf15bef, v21
    v_mul_f32 v22, 0x3cf15bef, v22
    v_mul_f32 v23, 0x3cf15bef, v23
    v_cvt_pk_bf16_f32 v52, v20, v21
    v_cvt_pk_bf16_f32 v54, v22, v23
    s_mov_b64 exec, s[58:59]
    buffer_store_dwordx4 v[52:55], v11, s[44:47], s51 offen sc1
    s_mov_b64 exec, -1
    v_mov_b32 v12, 0
    s_mov_b64 exec, 1
    buffer_store_dword v13, v12, s[44:47], s53 offen sc1
    s_mov_b64 exec, -1
L_c_done:
    s_mov_b32 s36, s26
    s_and_b32 s37, s27, 0xffff
    s_mov_b32 s38, 0x120000
    s_mov_b32 s39, 0x20000
    s_cmp_ge_u32 s6, 18
    s_cbranch_scc1 L_fin
    s_and_b32 s52, s5, 3
    s_mul_i32 s52, s52, 18
    s_min_u32 s54, s6, 17
    s_add_u32 s52, s52, s54
    s_lshr_b32 s49, s52, 3
    s_and_b32 s54, s52, 7
    s_lshr_b32 s56, s5, 2
    s_lshl_b32 s48, s56, 3
    s_add_u32 s48, s48, s54
    s_and_b32 s50, s3, 3
    s_lshr_b32 s51, s3, 2
    s_lshl_b32 s57, s49, 7
    s_lshl_b32 s53, s48, 3
    s_add_u32 s53, s53, s3
    s_mul_i32 s53, s53, 9216
    s_lshl_b32 s52, s57, 1
    s_add_u32 s53, s53, s52
    v_lshrrev_b32 v235, 4, v0
    v_mul_u32_u24 v235, 2304, v235
    v_and_b32 v12, 15, v0
    v_lshl_add_u32 v235, v12, 4, v235
    s_mul_i32 s55, s56, 36
    s_lshl_b32 s52, s49, 2
    s_add_u32 s55, s55, s52
    s_add_u32 s55, s55, s50
    s_lshl_b32 s55, s55, 4
    s_lshl_b32 s52, s51, 3
    s_add_u32 s55, s55, s52
    s_lshl_b32 s58, s55, 6
    s_add_u32 s58, s58, 7733248
    s_lshl_b32 s55, s55, 10
    s_add_u32 s55, s55, 5570560
    v_and_b32 v9, 3, v0
    v_lshlrev_b32 v9, 7, v9
    v_add_u32 v10, s58, v9
    s_lshl_b32 s52, s48, 3
    s_add_u32 s52, s52, s3
    s_mul_i32 s52, s52, 768
    s_add_u32 s52, s52, 7471104
    v_min_u32 v11, 5, v0
    v_lshlrev_b32 v11, 7, v11
    v_add_u32 v11, s52, v11
    v_cmp_gt_u32 vcc, 8, v0
    v_and_b32 v12, 15, v0
    v_lshrrev_b32 v9, 4, v0
    v_cndmask_b32 v10, v10, v11, vcc
    s_lshl_b32 s52, s3, 2
    v_add_u32 v9, s52, v9
    v_lshlrev_b32 v19, 10, v9
    v_lshl_add_u32 v19, v12, 4, v19
    v_lshrrev_b32 v11, 1, v12
    v_mul_u32_u24 v21, 528, v11
    v_lshl_add_u32 v21, v9, 4, v21
    v_and_b32 v11, 1, v0
    v_lshl_add_u32 v21, v11, 3, v21
    v_lshl_add_u32 v20, v7, 4, v1
    s_mul_i32 s52, s51, 8448
    v_add_u32 v20, s52, v20
    v_lshlrev_b32 v9, 5, v12
    ds_read_b128 v[44:47], v9 offset:36864
    ds_read_b128 v[48:51], v9 offset:36880
    s_lshl_b32 s52, s48, 15
    s_add_u32 s52, s52, 6815744
    v_mov_b32 v22, v10
    s_mov_b32 s60, 0
L_lp_18:
    buffer_load_dword v23, v22, s[44:47], 0 offen sc1
    s_waitcnt vmcnt(0)
    v_cmp_ne_u32 vcc, s4, v23
    s_and_b32 s61, vcc_lo, 255
    s_cbranch_scc0 L_lpd_19
    s_lshr_b32 s61, vcc_lo, 8
    s_or_b32 s61, s61, s60
    s_cbranch_scc1 L_nu_20
    buffer_load_dwordx4 v[96:99], v1, s[44:47], s55 offen offset:0 sc1
    buffer_load_dwordx4 v[100:103], v1, s[44:47], s55 offen offset:1024 sc1
    buffer_load_dwordx4 v[104:107], v1, s[44:47], s55 offen offset:2048 sc1
    buffer_load_dwordx4 v[108:111], v1, s[44:47], s55 offen offset:3072 sc1
    s_add_u32 s55, s55, 4096
    buffer_load_dwordx4 v[112:115], v1, s[44:47], s55 offen offset:0 sc1
    buffer_load_dwordx4 v[116:119], v1, s[44:47], s55 offen offset:1024 sc1
    buffer_load_dwordx4 v[120:123], v1, s[44:47], s55 offen offset:2048 sc1
    buffer_load_dwordx4 v[124:127], v1, s[44:47], s55 offen offset:3072 sc1
    s_mov_b32 s60, 1
L_nu_20:
    s_sleep 1
    s_sub_u32 s7, s7, 1
    s_cmp_lg_u32 s7, 0
    s_cbranch_scc1 L_lp_18
    s_mov_b32 s7, 1
L_lpd_19:
    buffer_load_dwordx4 v[24:27], v19, s[44:47], s52 offen offset:0 sc1
    buffer_load_dwordx4 v[28:31], v19, s[44:47], s52 offen offset:256 sc1
    buffer_load_dwordx4 v[32:35], v19, s[44:47], s52 offen offset:512 sc1
    buffer_load_dwordx4 v[36:39], v19, s[44:47], s52 offen offset:768 sc1
    s_lshr_b32 s61, vcc_lo, 8
    s_or_b32 s61, s61, s60
    s_cbranch_scc1 L_nu2_23
    buffer_load_dwordx4 v[96:99], v1, s[44:47], s55 offen offset:0 sc1
    buffer_load_dwordx4 v[100:103], v1, s[44:47], s55 offen offset:1024 sc1
    buffer_load_dwordx4 v[104:107], v1, s[44:47], s55 offen offset:2048 sc1
    buffer_load_dwordx4 v[108:111], v1, s[44:47], s55 offen offset:3072 sc1
    s_add_u32 s55, s55, 4096
    buffer_load_dwordx4 v[112:115], v1, s[44:47], s55 offen offset:0 sc1
    buffer_load_dwordx4 v[116:119], v1, s[44:47], s55 offen offset:1024 sc1
    buffer_load_dwordx4 v[120:123], v1, s[44:47], s55 offen offset:2048 sc1
    buffer_load_dwordx4 v[124:127], v1, s[44:47], s55 offen offset:3072 sc1
    s_mov_b32 s60, 1
    s_waitcnt vmcnt(8)
    s_branch L_lv_21_c
L_nu2_23:
    buffer_load_dword v23, v22, s[44:47], 0 offen sc1
    s_waitcnt vmcnt(1)
    s_branch L_lv_21_c
L_lv_21:
    buffer_load_dwordx4 v[24:27], v19, s[44:47], s52 offen offset:0 sc1
    buffer_load_dwordx4 v[28:31], v19, s[44:47], s52 offen offset:256 sc1
    buffer_load_dwordx4 v[32:35], v19, s[44:47], s52 offen offset:512 sc1
    buffer_load_dwordx4 v[36:39], v19, s[44:47], s52 offen offset:768 sc1
    s_waitcnt vmcnt(0)
L_lv_21_c:
    v_min_u32 v10, v25, v27
    v_max_u32 v11, v25, v27
    v_min3_u32 v10, v10, v29, v31
    v_max3_u32 v11, v11, v29, v31
    v_min3_u32 v10, v10, v33, v35
    v_max3_u32 v11, v11, v33, v35
    v_min3_u32 v10, v10, v37, v39
    v_max3_u32 v11, v11, v37, v39
    v_cmp_ne_u32 vcc, s4, v10
    v_cmp_ne_u32 s[62:63], s4, v11
    s_or_b64 vcc, vcc, s[62:63]
    s_cbranch_vccz L_lvd_22
    s_sub_u32 s7, s7, 1
    s_cmp_lg_u32 s7, 0
    s_cbranch_scc1 L_lv_21
    s_mov_b32 s7, 1
L_lvd_22:
    v_lshlrev_b32 v56, 16, v24
    v_and_b32 v57, 0xffff0000, v24
    v_lshlrev_b32 v58, 16, v26
    v_and_b32 v59, 0xffff0000, v26
    v_lshlrev_b32 v60, 16, v28
    v_and_b32 v61, 0xffff0000, v28
    v_lshlrev_b32 v62, 16, v30
    v_and_b32 v63, 0xffff0000, v30
    v_lshlrev_b32 v64, 16, v32
    v_and_b32 v65, 0xffff0000, v32
    v_lshlrev_b32 v66, 16, v34
    v_and_b32 v67, 0xffff0000, v34
    v_lshlrev_b32 v68, 16, v36
    v_and_b32 v69, 0xffff0000, v36
    v_lshlrev_b32 v70, 16, v38
    v_and_b32 v71, 0xffff0000, v38
    v_max3_f32 v17, v56, v57, v58
    v_max3_f32 v18, v59, v60, v61
    v_max3_f32 v17, v17, v62, v63
    v_max3_f32 v18, v18, v64, v65
    v_max3_f32 v17, v17, v66, v67
    v_max3_f32 v18, v18, v68, v69
    v_max3_f32 v17, v17, v70, v71
    v_max_f32 v17, v17, v18
    s_nop 1
    v_max_f32_dpp v17, v17, v17 quad_perm:[1,0,3,2] row_mask:0xf bank_mask:0xf
    s_nop 1
    v_max_f32_dpp v17, v17, v17 quad_perm:[2,3,0,1] row_mask:0xf bank_mask:0xf
    s_nop 1
    v_max_f32_dpp v17, v17, v17 row_half_mirror row_mask:0xf bank_mask:0xf
    s_nop 1
    v_max_f32_dpp v17, v17, v17 row_mirror row_mask:0xf bank_mask:0xf
    s_mov_b32 s58, 0x3fb8aa3b
    v_mul_f32 v17, s58, v17
    v_fma_f32 v56, v56, s58, -v17
    v_fma_f32 v57, v57, s58, -v17
    v_fma_f32 v58, v58, s58, -v17
    v_fma_f32 v59, v59, s58, -v17
    v_fma_f32 v60, v60, s58, -v17
    v_fma_f32 v61, v61, s58, -v17
    v_fma_f32 v62, v62, s58, -v17
    v_fma_f32 v63, v63, s58, -v17
    v_fma_f32 v64, v64, s58, -v17
    v_fma_f32 v65, v65, s58, -v17
    v_fma_f32 v66, v66, s58, -v17
    v_fma_f32 v67, v67, s58, -v17
    v_fma_f32 v68, v68, s58, -v17
    v_fma_f32 v69, v69, s58, -v17
    v_fma_f32 v70, v70, s58, -v17
    v_fma_f32 v71, v71, s58, -v17
    v_exp_f32 v56, v56
    v_exp_f32 v57, v57
    v_exp_f32 v58, v58
    v_exp_f32 v59, v59
    v_exp_f32 v60, v60
    v_exp_f32 v61, v61
    v_exp_f32 v62, v62
    v_exp_f32 v63, v63
    v_exp_f32 v64, v64
    v_exp_f32 v65, v65
    v_exp_f32 v66, v66
    v_exp_f32 v67, v67
    v_exp_f32 v68, v68
    v_exp_f32 v69, v69
    v_exp_f32 v70, v70
    v_exp_f32 v71, v71
    v_add_f32 v18, v56, v57
    v_add_f32 v17, v58, v59
    v_add_f32 v18, v18, v60
    v_add_f32 v17, v17, v61
    v_add_f32 v18, v18, v62
    v_add_f32 v17, v17, v63
    v_add_f32 v18, v18, v64
    v_add_f32 v17, v17, v65
    v_add_f32 v18, v18, v66
    v_add_f32 v17, v17, v67
    v_add_f32 v18, v18, v68
    v_add_f32 v17, v17, v69
    v_add_f32 v18, v18, v70
    v_add_f32 v17, v17, v71
    v_add_f32 v18, v18, v17
    s_nop 1
    v_add_f32_dpp v18, v18, v18 quad_perm:[1,0,3,2] row_mask:0xf bank_mask:0xf
    s_nop 1
    v_add_f32_dpp v18, v18, v18 quad_perm:[2,3,0,1] row_mask:0xf bank_mask:0xf
    s_nop 1
    v_add_f32_dpp v18, v18, v18 row_half_mirror row_mask:0xf bank_mask:0xf
    s_nop 1
    v_add_f32_dpp v18, v18, v18 row_mirror row_mask:0xf bank_mask:0xf
    v_rcp_f32 v18, v18
    s_nop 0
    v_mul_f32 v56, v56, v18
    v_mul_f32 v57, v57, v18
    v_mul_f32 v58, v58, v18
    v_mul_f32 v59, v59, v18
    v_mul_f32 v60, v60, v18
    v_mul_f32 v61, v61, v18
    v_mul_f32 v62, v62, v18
    v_mul_f32 v63, v63, v18
    v_mul_f32 v64, v64, v18
    v_mul_f32 v65, v65, v18
    v_mul_f32 v66, v66, v18
    v_mul_f32 v67, v67, v18
    v_mul_f32 v68, v68, v18
    v_mul_f32 v69, v69, v18
    v_mul_f32 v70, v70, v18
    v_mul_f32 v71, v71, v18
    v_cvt_pk_bf16_f32 v24, v56, v57
    v_cvt_pk_bf16_f32 v25, v58, v59
    v_cvt_pk_bf16_f32 v26, v60, v61
    v_cvt_pk_bf16_f32 v27, v62, v63
    v_cvt_pk_bf16_f32 v28, v64, v65
    v_cvt_pk_bf16_f32 v29, v66, v67
    v_cvt_pk_bf16_f32 v30, v68, v69
    v_cvt_pk_bf16_f32 v31, v70, v71
    ds_write_b64 v21, v[24:25] offset:40960
    ds_write_b64 v21, v[26:27] offset:45184
    ds_write_b64 v21, v[28:29] offset:49408
    ds_write_b64 v21, v[30:31] offset:53632
    s_cmp_lg_u32 s60, 0
    s_cbranch_scc1 L_hu_24
L_up_25:
    s_waitcnt vmcnt(0)
    v_cmp_ne_u32 vcc, s4, v23
    s_cbranch_vccz L_upd_26
    buffer_load_dword v23, v22, s[44:47], 0 offen sc1
    s_sub_u32 s7, s7, 1
    s_cmp_lg_u32 s7, 0
    s_cbranch_scc1 L_up_25
    s_mov_b32 s7, 1
L_upd_26:
    buffer_load_dwordx4 v[96:99], v1, s[44:47], s55 offen offset:0 sc1
    buffer_load_dwordx4 v[100:103], v1, s[44:47], s55 offen offset:1024 sc1
    buffer_load_dwordx4 v[104:107], v1, s[44:47], s55 offen offset:2048 sc1
    buffer_load_dwordx4 v[108:111], v1, s[44:47], s55 offen offset:3072 sc1
    s_add_u32 s55, s55, 4096
    buffer_load_dwordx4 v[112:115], v1, s[44:47], s55 offen offset:0 sc1
    buffer_load_dwordx4 v[116:119], v1, s[44:47], s55 offen offset:1024 sc1
    buffer_load_dwordx4 v[120:123], v1, s[44:47], s55 offen offset:2048 sc1
    buffer_load_dwordx4 v[124:127], v1, s[44:47], s55 offen offset:3072 sc1
    s_mov_b32 s60, 1
L_hu_24:
    s_waitcnt lgkmcnt(0)
    s_barrier
    ds_read_b128 v[128:131], v20 offset:40960
    ds_read_b128 v[132:135], v20 offset:42016
    ds_read_b128 v[136:139], v20 offset:43072
    ds_read_b128 v[140:143], v20 offset:44128
    ds_read_b128 v[144:147], v20 offset:45184
    ds_read_b128 v[148:151], v20 offset:46240
    ds_read_b128 v[152:155], v20 offset:47296
    ds_read_b128 v[156:159], v20 offset:48352
    s_mul_i32 s52, s51, 16896
    s_lshl_b32 s58, s50, 7
    s_add_u32 s52, s52, s58
    s_add_u32 s52, s52, 65536
    v_mul_u32_u24 v10, 528, v8
    v_lshl_add_u32 v10, v7, 5, v10
    v_add_u32 v10, s52, v10
    v_lshrrev_b32 v11, 4, v0
    v_mul_u32_u24 v11, 528, v11
    s_mul_i32 s52, s3, 2112
    s_add_u32 s52, s52, 65536
    v_add3_u32 v11, v11, v9, s52
    s_waitcnt vmcnt(7) lgkmcnt(7)
    v_mfma_f32_32x32x16_bf16 v[80:95], v[96:99], v[128:131], 0
    s_waitcnt vmcnt(6) lgkmcnt(6)
    v_mfma_f32_32x32x16_bf16 v[80:95], v[100:103], v[132:135], v[80:95]
    s_waitcnt vmcnt(5) lgkmcnt(5)
    v_mfma_f32_32x32x16_bf16 v[80:95], v[104:107], v[136:139], v[80:95]
    s_waitcnt vmcnt(4) lgkmcnt(4)
    v_mfma_f32_32x32x16_bf16 v[80:95], v[108:111], v[140:143], v[80:95]
    s_waitcnt vmcnt(3) lgkmcnt(3)
    v_mfma_f32_32x32x16_bf16 v[80:95], v[112:115], v[144:147], v[80:95]
    s_waitcnt vmcnt(2) lgkmcnt(2)
    v_mfma_f32_32x32x16_bf16 v[80:95], v[116:119], v[148:151], v[80:95]
    s_waitcnt vmcnt(1) lgkmcnt(1)
    v_mfma_f32_32x32x16_bf16 v[80:95], v[120:123], v[152:155], v[80:95]
    s_waitcnt vmcnt(0) lgkmcnt(0)
    v_mfma_f32_32x32x16_bf16 v[80:95], v[124:127], v[156:159], v[80:95]
    v_lshlrev_b32 v56, 16, v236
    v_and_b32 v57, 0xffff0000, v236
    v_lshlrev_b32 v58, 16, v237
    v_and_b32 v59, 0xffff0000, v237
    v_lshlrev_b32 v60, 16, v238
    v_and_b32 v61, 0xffff0000, v238
    v_lshlrev_b32 v62, 16, v239
    v_and_b32 v63, 0xffff0000, v239
    s_nop 3
    ds_write_b128 v10, v[80:83] offset:0
    ds_write_b128 v10, v[84:87] offset:16
    ds_write_b128 v10, v[88:91] offset:64
    ds_write_b128 v10, v[92:95] offset:80
    s_waitcnt lgkmcnt(0)
    s_barrier
    ds_read_b128 v[80:83], v11
    ds_read_b128 v[72:75], v11 offset:16896
    ds_read_b128 v[84:87], v11 offset:16
    ds_read_b128 v[76:79], v11 offset:16912
    s_waitcnt vmcnt(0) lgkmcnt(2)
    v_add_f32 v80, v80, v72
    v_add_f32 v81, v81, v73
    v_add_f32 v82, v82, v74
    v_add_f32 v83, v83, v75
    s_waitcnt lgkmcnt(0)
    v_add_f32 v84, v84, v76
    v_add_f32 v85, v85, v77
    v_add_f32 v86, v86, v78
    v_add_f32 v87, v87, v79
    v_cvt_pk_bf16_f32 v72, v80, v81
    v_cvt_pk_bf16_f32 v73, v82, v83
    v_cvt_pk_bf16_f32 v74, v84, v85
    v_cvt_pk_bf16_f32 v75, v86, v87
    v_lshlrev_b32 v80, 16, v72
    v_and_b32 v81, 0xffff0000, v72
    v_lshlrev_b32 v82, 16, v73
    v_and_b32 v83, 0xffff0000, v73
    v_lshlrev_b32 v84, 16, v74
    v_and_b32 v85, 0xffff0000, v74
    v_lshlrev_b32 v86, 16, v75
    v_and_b32 v87, 0xffff0000, v75
    v_mul_f32 v80, v80, v44
    v_mul_f32 v81, v81, v45
    v_mul_f32 v82, v82, v46
    v_mul_f32 v83, v83, v47
    v_mul_f32 v84, v84, v48
    v_mul_f32 v85, v85, v49
    v_mul_f32 v86, v86, v50
    v_mul_f32 v87, v87, v51
    v_cvt_pk_bf16_f32 v72, v80, v81
    v_cvt_pk_bf16_f32 v73, v82, v83
    v_cvt_pk_bf16_f32 v74, v84, v85
    v_cvt_pk_bf16_f32 v75, v86, v87
    v_lshlrev_b32 v80, 16, v72
    v_and_b32 v81, 0xffff0000, v72
    v_lshlrev_b32 v82, 16, v73
    v_and_b32 v83, 0xffff0000, v73
    v_lshlrev_b32 v84, 16, v74
    v_and_b32 v85, 0xffff0000, v74
    v_lshlrev_b32 v86, 16, v75
    v_and_b32 v87, 0xffff0000, v75
    v_add_f32 v80, v80, v56
    v_add_f32 v81, v81, v57
    v_add_f32 v82, v82, v58
    v_add_f32 v83, v83, v59
    v_add_f32 v84, v84, v60
    v_add_f32 v85, v85, v61
    v_add_f32 v86, v86, v62
    v_add_f32 v87, v87, v63
    v_cvt_pk_bf16_f32 v72, v80, v81
    v_cvt_pk_bf16_f32 v73, v82, v83
    v_cvt_pk_bf16_f32 v74, v84, v85
    v_cvt_pk_bf16_f32 v75, v86, v87
    buffer_store_dwordx4 v[72:75], v235, s[36:39], s53 offen
L_fin:
L_end:
    s_endpgm
L_owner:
    s_mov_b32 s52, s2
    s_cmp_ge_u32 s52, 36
    s_cbranch_scc1 L_o_pref
    s_lshr_b32 s53, s52, 1
    s_and_b32 s49, s52, 1
    s_waitcnt vmcnt(0)
    s_barrier
    v_and_b32 v12, 7, v0
    v_xor_b32 v9, s3, v12
    v_lshlrev_b32 v9, 4, v9
    v_lshl_add_u32 v9, v0, 7, v9
    ds_read_b128 v[96:99], v9 offset:0
    ds_read_b128 v[100:103], v9 offset:8192
    ds_read_b128 v[104:107], v9 offset:16384
    ds_read_b128 v[108:111], v9 offset:24576
    s_lshl_b32 s57, s49, 12
    s_add_u32 s57, s57, 0
    s_mul_i32 s58, s52, 18432
    s_lshl_b32 s51, s3, 7
    s_add_u32 s58, s58, s51
    s_add_u32 s58, s58, 4849664
    s_add_u32 s59, s58, 8192
    v_lshlrev_b32 v10, 4, v12
    v_min_u32 v11, 1, v6
    v_lshl_add_u32 v11, v11, 10, v10
    v_add_u32 v11, 16384, v11
    v_lshl_add_u32 v10, v6, 10, v10
    v_cmp_gt_u32 vcc, 16, v0
    v_mul_u32_u24 v20, 73728, v7
    v_lshl_add_u32 v20, v8, 4, v20
    v_cndmask_b32 v17, 0, 1.0, vcc
    v_bfe_u32 v18, v0, 2, 1
    v_cvt_f32_u32 v18, v18
    s_mul_i32 s51, s49, 589824
    s_lshl_b32 s60, s53, 12
    s_add_u32 s51, s51, s60
    s_lshl_b32 s60, s3, 9
    s_add_u32 s51, s51, s60
    s_add_u32 s51, s51, 131072
    s_waitcnt lgkmcnt(0)
    v_lshlrev_b32 v48, 16, v96
    v_and_b32 v49, 0xffff0000, v96
    v_lshlrev_b32 v50, 16, v97
    v_and_b32 v51, 0xffff0000, v97
    v_lshlrev_b32 v52, 16, v98
    v_and_b32 v53, 0xffff0000, v98
    v_lshlrev_b32 v54, 16, v99
    v_and_b32 v55, 0xffff0000, v99
    v_lshlrev_b32 v56, 16, v100
    v_and_b32 v57, 0xffff0000, v100
    v_lshlrev_b32 v58, 16, v101
    v_and_b32 v59, 0xffff0000, v101
    v_lshlrev_b32 v60, 16, v102
    v_and_b32 v61, 0xffff0000, v102
    v_lshlrev_b32 v62, 16, v103
    v_and_b32 v63, 0xffff0000, v103
    v_lshlrev_b32 v64, 16, v104
    v_and_b32 v65, 0xffff0000, v104
    v_lshlrev_b32 v66, 16, v105
    v_and_b32 v67, 0xffff0000, v105
    v_lshlrev_b32 v68, 16, v106
    v_and_b32 v69, 0xffff0000, v106
    v_lshlrev_b32 v70, 16, v107
    v_and_b32 v71, 0xffff0000, v107
    v_lshlrev_b32 v72, 16, v108
    v_and_b32 v73, 0xffff0000, v108
    v_lshlrev_b32 v74, 16, v109
    v_and_b32 v75, 0xffff0000, v109
    v_lshlrev_b32 v76, 16, v110
    v_and_b32 v77, 0xffff0000, v110
    v_lshlrev_b32 v78, 16, v111
    v_and_b32 v79, 0xffff0000, v111
    s_lshl_b32 s60, s3, 9
    v_lshlrev_b32 v184, 4, v8
    v_add_u32 v184, s60, v184
    v_add_u32 v185, 152064, v184
    v_add_u32 v186, 152064, v1
L_gp_27:
    buffer_load_dwordx4 v[32:35], v184, s[44:47], s57 offen sc1
    s_waitcnt vmcnt(0)
    v_cmp_ne_u32 vcc, s4, v33
    v_cmp_ne_u32 s[62:63], s4, v35
    s_or_b64 vcc, vcc, s[62:63]
    s_cbranch_vccz L_gpd_28
    s_sleep 2
    s_sub_u32 s7, s7, 1
    s_cmp_lg_u32 s7, 0
    s_cbranch_scc1 L_gp_27
    s_mov_b32 s7, 1
L_gpd_28:
    ds_write_b128 v185, v[32:35]
    s_waitcnt lgkmcnt(0)
    s_barrier
    ds_read_b128 v[32:35], v186 offset:0
    ds_read_b128 v[36:39], v186 offset:1024
    ds_read_b128 v[40:43], v186 offset:2048
    ds_read_b128 v[44:47], v186 offset:3072
    s_waitcnt lgkmcnt(0)
    v_sub_f32 v48, v48, v32
    v_sub_f32 v49, v49, v32
    v_sub_f32 v50, v50, v32
    v_sub_f32 v51, v51, v32
    v_sub_f32 v52, v52, v32
    v_sub_f32 v53, v53, v32
    v_sub_f32 v54, v54, v32
    v_sub_f32 v55, v55, v32
    v_sub_f32 v56, v56, v36
    v_sub_f32 v57, v57, v36
    v_sub_f32 v58, v58, v36
    v_sub_f32 v59, v59, v36
    v_sub_f32 v60, v60, v36
    v_sub_f32 v61, v61, v36
    v_sub_f32 v62, v62, v36
    v_sub_f32 v63, v63, v36
    v_sub_f32 v64, v64, v40
    v_sub_f32 v65, v65, v40
    v_sub_f32 v66, v66, v40
    v_sub_f32 v67, v67, v40
    v_sub_f32 v68, v68, v40
    v_sub_f32 v69, v69, v40
    v_sub_f32 v70, v70, v40
    v_sub_f32 v71, v71, v40
    v_sub_f32 v72, v72, v44
    v_sub_f32 v73, v73, v44
    v_sub_f32 v74, v74, v44
    v_sub_f32 v75, v75, v44
    v_sub_f32 v76, v76, v44
    v_sub_f32 v77, v77, v44
    v_sub_f32 v78, v78, v44
    v_sub_f32 v79, v79, v44
    v_cvt_pk_bf16_f32 v96, v48, v49
    v_cvt_pk_bf16_f32 v97, v50, v51
    v_cvt_pk_bf16_f32 v98, v52, v53
    v_cvt_pk_bf16_f32 v99, v54, v55
    v_cvt_pk_bf16_f32 v100, v56, v57
    v_cvt_pk_bf16_f32 v101, v58, v59
    v_cvt_pk_bf16_f32 v102, v60, v61
    v_cvt_pk_bf16_f32 v103, v62, v63
    v_cvt_pk_bf16_f32 v104, v64, v65
    v_cvt_pk_bf16_f32 v105, v66, v67
    v_cvt_pk_bf16_f32 v106, v68, v69
    v_cvt_pk_bf16_f32 v107, v70, v71
    v_cvt_pk_bf16_f32 v108, v72, v73
    v_cvt_pk_bf16_f32 v109, v74, v75
    v_cvt_pk_bf16_f32 v110, v76, v77
    v_cvt_pk_bf16_f32 v111, v78, v79
    v_lshlrev_b32 v48, 16, v96
    v_and_b32 v49, 0xffff0000, v96
    v_lshlrev_b32 v50, 16, v97
    v_and_b32 v51, 0xffff0000, v97
    v_lshlrev_b32 v52, 16, v98
    v_and_b32 v53, 0xffff0000, v98
    v_lshlrev_b32 v54, 16, v99
    v_and_b32 v55, 0xffff0000, v99
    v_lshlrev_b32 v56, 16, v100
    v_and_b32 v57, 0xffff0000, v100
    v_lshlrev_b32 v58, 16, v101
    v_and_b32 v59, 0xffff0000, v101
    v_lshlrev_b32 v60, 16, v102
    v_and_b32 v61, 0xffff0000, v102
    v_lshlrev_b32 v62, 16, v103
    v_and_b32 v63, 0xffff0000, v103
    v_lshlrev_b32 v64, 16, v104
    v_and_b32 v65, 0xffff0000, v104
    v_lshlrev_b32 v66, 16, v105
    v_and_b32 v67, 0xffff0000, v105
    v_lshlrev_b32 v68, 16, v106
    v_and_b32 v69, 0xffff0000, v106
    v_lshlrev_b32 v70, 16, v107
    v_and_b32 v71, 0xffff0000, v107
    v_lshlrev_b32 v72, 16, v108
    v_and_b32 v73, 0xffff0000, v108
    v_lshlrev_b32 v74, 16, v109
    v_and_b32 v75, 0xffff0000, v109
    v_lshlrev_b32 v76, 16, v110
    v_and_b32 v77, 0xffff0000, v110
    v_lshlrev_b32 v78, 16, v111
    v_and_b32 v79, 0xffff0000, v111
    buffer_load_dwordx4 v[112:115], v10, s[44:47], s58 offen sc1
    buffer_load_dwordx4 v[116:119], v10, s[44:47], s59 offen sc1
    buffer_load_dwordx4 v[120:123], v11, s[44:47], s58 offen sc1
    v_mul_f32 v48, v48, v34
    v_mul_f32 v49, v49, v34
    v_mul_f32 v50, v50, v34
    v_mul_f32 v51, v51, v34
    v_mul_f32 v52, v52, v34
    v_mul_f32 v53, v53, v34
    v_mul_f32 v54, v54, v34
    v_mul_f32 v55, v55, v34
    v_mul_f32 v56, v56, v38
    v_mul_f32 v57, v57, v38
    v_mul_f32 v58, v58, v38
    v_mul_f32 v59, v59, v38
    v_mul_f32 v60, v60, v38
    v_mul_f32 v61, v61, v38
    v_mul_f32 v62, v62, v38
    v_mul_f32 v63, v63, v38
    v_mul_f32 v64, v64, v42
    v_mul_f32 v65, v65, v42
    v_mul_f32 v66, v66, v42
    v_mul_f32 v67, v67, v42
    v_mul_f32 v68, v68, v42
    v_mul_f32 v69, v69, v42
    v_mul_f32 v70, v70, v42
    v_mul_f32 v71, v71, v42
    v_mul_f32 v72, v72, v46
    v_mul_f32 v73, v73, v46
    v_mul_f32 v74, v74, v46
    v_mul_f32 v75, v75, v46
    v_mul_f32 v76, v76, v46
    v_mul_f32 v77, v77, v46
    v_mul_f32 v78, v78, v46
    v_mul_f32 v79, v79, v46
    v_cvt_pk_bf16_f32 v96, v48, v49
    v_cvt_pk_bf16_f32 v97, v50, v51
    v_cvt_pk_bf16_f32 v98, v52, v53
    v_cvt_pk_bf16_f32 v99, v54, v55
    v_cvt_pk_bf16_f32 v100, v56, v57
    v_cvt_pk_bf16_f32 v101, v58, v59
    v_cvt_pk_bf16_f32 v102, v60, v61
    v_cvt_pk_bf16_f32 v103, v62, v63
    v_cvt_pk_bf16_f32 v104, v64, v65
    v_cvt_pk_bf16_f32 v105, v66, v67
    v_cvt_pk_bf16_f32 v106, v68, v69
    v_cvt_pk_bf16_f32 v107, v70, v71
    v_cvt_pk_bf16_f32 v108, v72, v73
    v_cvt_pk_bf16_f32 v109, v74, v75
    v_cvt_pk_bf16_f32 v110, v76, v77
    v_cvt_pk_bf16_f32 v111, v78, v79
    v_lshlrev_b32 v48, 16, v96
    v_and_b32 v49, 0xffff0000, v96
    v_lshlrev_b32 v50, 16, v97
    v_and_b32 v51, 0xffff0000, v97
    v_lshlrev_b32 v52, 16, v98
    v_and_b32 v53, 0xffff0000, v98
    v_lshlrev_b32 v54, 16, v99
    v_and_b32 v55, 0xffff0000, v99
    v_lshlrev_b32 v56, 16, v100
    v_and_b32 v57, 0xffff0000, v100
    v_lshlrev_b32 v58, 16, v101
    v_and_b32 v59, 0xffff0000, v101
    v_lshlrev_b32 v60, 16, v102
    v_and_b32 v61, 0xffff0000, v102
    v_lshlrev_b32 v62, 16, v103
    v_and_b32 v63, 0xffff0000, v103
    v_lshlrev_b32 v64, 16, v104
    v_and_b32 v65, 0xffff0000, v104
    v_lshlrev_b32 v66, 16, v105
    v_and_b32 v67, 0xffff0000, v105
    v_lshlrev_b32 v68, 16, v106
    v_and_b32 v69, 0xffff0000, v106
    v_lshlrev_b32 v70, 16, v107
    v_and_b32 v71, 0xffff0000, v107
    v_lshlrev_b32 v72, 16, v108
    v_and_b32 v73, 0xffff0000, v108
    v_lshlrev_b32 v74, 16, v109
    v_and_b32 v75, 0xffff0000, v109
    v_lshlrev_b32 v76, 16, v110
    v_and_b32 v77, 0xffff0000, v110
    v_lshlrev_b32 v78, 16, v111
    v_and_b32 v79, 0xffff0000, v111
L_pp_29:
    s_waitcnt vmcnt(0)
    v_min3_u32 v184, v113, v115, v117
    v_max3_u32 v185, v113, v115, v117
    v_min3_u32 v184, v184, v119, v121
    v_max3_u32 v185, v185, v119, v121
    v_min_u32 v184, v184, v123
    v_max_u32 v185, v185, v123
    v_cmp_ne_u32 vcc, s4, v184
    v_cmp_ne_u32 s[62:63], s4, v185
    s_or_b64 vcc, vcc, s[62:63]
    s_cbranch_vccz L_ppd_30
    s_sub_u32 s7, s7, 1
    s_cmp_eq_u32 s7, 0
    s_cbranch_scc1 L_ppd_30
    buffer_load_dwordx4 v[112:115], v10, s[44:47], s58 offen sc1
    buffer_load_dwordx4 v[116:119], v10, s[44:47], s59 offen sc1
    buffer_load_dwordx4 v[120:123], v11, s[44:47], s58 offen sc1
    s_branch L_pp_29
L_ppd_30:
    s_max_u32 s7, s7, 1
    v_add_f32 v112, v112, v116
    v_add_f32 v114, v114, v118
    v_fmac_f32 v112, v17, v120
    v_fmac_f32 v114, v17, v122
    s_nop 1
    v_permlane32_swap_b32 v112, v114
    s_nop 0
    v_add_f32 v112, v112, v114
    v_mov_b32 v114, v112
    s_nop 1
    v_permlane16_swap_b32 v112, v114
    s_nop 0
    v_add_f32 v112, v112, v114
    s_nop 1
    v_add_f32_dpp v112, v112, v112 row_ror:8 row_mask:0xf bank_mask:0xf
    v_cvt_pk_bf16_f32 v112, v112, v112
    v_lshlrev_b32 v112, 16, v112
    v_add_f32 v112, v112, v18
    v_cvt_pk_bf16_f32 v112, v112, v112
    v_lshlrev_b32 v112, 16, v112
    s_nop 0
    v_readlane_b32 s40, v112, 4
    v_readlane_b32 s41, v112, 36
    v_readlane_b32 s42, v112, 5
    v_readlane_b32 s43, v112, 37
    v_readlane_b32 s9, v112, 6
    v_readlane_b32 s10, v112, 38
    v_readlane_b32 s11, v112, 7
    v_readlane_b32 s12, v112, 39
    v_readlane_b32 s32, v112, 0
    v_readlane_b32 s33, v112, 32
    v_readlane_b32 s34, v112, 1
    v_readlane_b32 s35, v112, 33
    v_readlane_b32 s36, v112, 2
    v_readlane_b32 s37, v112, 34
    v_readlane_b32 s38, v112, 3
    v_readlane_b32 s39, v112, 35
    v_mul_f32 v48, s40, v48
    v_mul_f32 v49, s41, v49
    v_mul_f32 v50, s42, v50
    v_mul_f32 v51, s43, v51
    v_mul_f32 v52, s9, v52
    v_mul_f32 v53, s10, v53
    v_mul_f32 v54, s11, v54
    v_mul_f32 v55, s12, v55
    v_cvt_pk_bf16_f32 v96, v48, v49
    v_cvt_pk_bf16_f32 v97, v50, v51
    v_cvt_pk_bf16_f32 v98, v52, v53
    v_cvt_pk_bf16_f32 v99, v54, v55
    v_lshlrev_b32 v48, 16, v96
    v_and_b32 v49, 0xffff0000, v96
    v_lshlrev_b32 v50, 16, v97
    v_and_b32 v51, 0xffff0000, v97
    v_lshlrev_b32 v52, 16, v98
    v_and_b32 v53, 0xffff0000, v98
    v_lshlrev_b32 v54, 16, v99
    v_and_b32 v55, 0xffff0000, v99
    v_add_f32 v48, s32, v48
    v_add_f32 v49, s33, v49
    v_add_f32 v50, s34, v50
    v_add_f32 v51, s35, v51
    v_add_f32 v52, s36, v52
    v_add_f32 v53, s37, v53
    v_add_f32 v54, s38, v54
    v_add_f32 v55, s39, v55
    v_cvt_pk_bf16_f32 v96, v48, v49
    v_cvt_pk_bf16_f32 v97, v50, v51
    v_cvt_pk_bf16_f32 v98, v52, v53
    v_cvt_pk_bf16_f32 v99, v54, v55
    buffer_store_dwordx4 v[96:99], v20, s[44:47], s51 offen sc1
    s_add_u32 s51, s51, 147456
    v_mul_f32 v56, s40, v56
    v_mul_f32 v57, s41, v57
    v_mul_f32 v58, s42, v58
    v_mul_f32 v59, s43, v59
    v_mul_f32 v60, s9, v60
    v_mul_f32 v61, s10, v61
    v_mul_f32 v62, s11, v62
    v_mul_f32 v63, s12, v63
    v_cvt_pk_bf16_f32 v100, v56, v57
    v_cvt_pk_bf16_f32 v101, v58, v59
    v_cvt_pk_bf16_f32 v102, v60, v61
    v_cvt_pk_bf16_f32 v103, v62, v63
    v_lshlrev_b32 v56, 16, v100
    v_and_b32 v57, 0xffff0000, v100
    v_lshlrev_b32 v58, 16, v101
    v_and_b32 v59, 0xffff0000, v101
    v_lshlrev_b32 v60, 16, v102
    v_and_b32 v61, 0xffff0000, v102
    v_lshlrev_b32 v62, 16, v103
    v_and_b32 v63, 0xffff0000, v103
    v_add_f32 v56, s32, v56
    v_add_f32 v57, s33, v57
    v_add_f32 v58, s34, v58
    v_add_f32 v59, s35, v59
    v_add_f32 v60, s36, v60
    v_add_f32 v61, s37, v61
    v_add_f32 v62, s38, v62
    v_add_f32 v63, s39, v63
    v_cvt_pk_bf16_f32 v100, v56, v57
    v_cvt_pk_bf16_f32 v101, v58, v59
    v_cvt_pk_bf16_f32 v102, v60, v61
    v_cvt_pk_bf16_f32 v103, v62, v63
    buffer_store_dwordx4 v[100:103], v20, s[44:47], s51 offen sc1
    s_add_u32 s51, s51, 147456
    v_mul_f32 v64, s40, v64
    v_mul_f32 v65, s41, v65
    v_mul_f32 v66, s42, v66
    v_mul_f32 v67, s43, v67
    v_mul_f32 v68, s9, v68
    v_mul_f32 v69, s10, v69
    v_mul_f32 v70, s11, v70
    v_mul_f32 v71, s12, v71
    v_cvt_pk_bf16_f32 v104, v64, v65
    v_cvt_pk_bf16_f32 v105, v66, v67
    v_cvt_pk_bf16_f32 v106, v68, v69
    v_cvt_pk_bf16_f32 v107, v70, v71
    v_lshlrev_b32 v64, 16, v104
    v_and_b32 v65, 0xffff0000, v104
    v_lshlrev_b32 v66, 16, v105
    v_and_b32 v67, 0xffff0000, v105
    v_lshlrev_b32 v68, 16, v106
    v_and_b32 v69, 0xffff0000, v106
    v_lshlrev_b32 v70, 16, v107
    v_and_b32 v71, 0xffff0000, v107
    v_add_f32 v64, s32, v64
    v_add_f32 v65, s33, v65
    v_add_f32 v66, s34, v66
    v_add_f32 v67, s35, v67
    v_add_f32 v68, s36, v68
    v_add_f32 v69, s37, v69
    v_add_f32 v70, s38, v70
    v_add_f32 v71, s39, v71
    v_cvt_pk_bf16_f32 v104, v64, v65
    v_cvt_pk_bf16_f32 v105, v66, v67
    v_cvt_pk_bf16_f32 v106, v68, v69
    v_cvt_pk_bf16_f32 v107, v70, v71
    buffer_store_dwordx4 v[104:107], v20, s[44:47], s51 offen sc1
    s_add_u32 s51, s51, 147456
    v_mul_f32 v72, s40, v72
    v_mul_f32 v73, s41, v73
    v_mul_f32 v74, s42, v74
    v_mul_f32 v75, s43, v75
    v_mul_f32 v76, s9, v76
    v_mul_f32 v77, s10, v77
    v_mul_f32 v78, s11, v78
    v_mul_f32 v79, s12, v79
    v_cvt_pk_bf16_f32 v108, v72, v73
    v_cvt_pk_bf16_f32 v109, v74, v75
    v_cvt_pk_bf16_f32 v110, v76, v77
    v_cvt_pk_bf16_f32 v111, v78, v79
    v_lshlrev_b32 v72, 16, v108
    v_and_b32 v73, 0xffff0000, v108
    v_lshlrev_b32 v74, 16, v109
    v_and_b32 v75, 0xffff0000, v109
    v_lshlrev_b32 v76, 16, v110
    v_and_b32 v77, 0xffff0000, v110
    v_lshlrev_b32 v78, 16, v111
    v_and_b32 v79, 0xffff0000, v111
    v_add_f32 v72, s32, v72
    v_add_f32 v73, s33, v73
    v_add_f32 v74, s34, v74
    v_add_f32 v75, s35, v75
    v_add_f32 v76, s36, v76
    v_add_f32 v77, s37, v77
    v_add_f32 v78, s38, v78
    v_add_f32 v79, s39, v79
    v_cvt_pk_bf16_f32 v108, v72, v73
    v_cvt_pk_bf16_f32 v109, v74, v75
    v_cvt_pk_bf16_f32 v110, v76, v77
    v_cvt_pk_bf16_f32 v111, v78, v79
    buffer_store_dwordx4 v[108:111], v20, s[44:47], s51 offen sc1
    s_mul_i32 s51, s49, 18
    s_add_u32 s51, s51, s53
    s_lshl_b32 s51, s51, 7
    s_add_u32 s51, s51, 8192
    s_waitcnt vmcnt(0)
    s_barrier
    s_cmp_lg_u32 s3, 0
    s_cbranch_scc1 L_fl_31
    v_mov_b32 v12, 0
    s_mov_b64 exec, 1
    buffer_store_dword v13, v12, s[44:47], s51 offen sc1
    s_mov_b64 exec, -1
L_fl_31:
L_o_pref:
    s_mov_b32 s32, s24
    s_and_b32 s33, s25, 0xffff
    s_mov_b32 s34, 0xf30000
    s_mov_b32 s35, 0x20000
    s_mov_b32 s40, s18
    s_and_b32 s41, s19, 0xffff
    s_mov_b32 s42, 0x1200
    s_mov_b32 s43, 0x20000
    s_sub_u32 s51, s52, 20
    s_cmp_ge_u32 s52, 16
    s_cselect_b32 s52, s51, s52
    s_cselect_b32 s51, 16, 0
    s_cmp_lt_u32 s52, s51
    s_cbranch_scc1 L_o_upd
    s_cmp_ge_u32 s52, 18
    s_cbranch_scc1 L_o_upd
    s_mul_i32 s50, s3, 144
    v_min_u32 v9, 17, v8
    v_lshlrev_b32 v9, 4, v9
    v_mul_u32_u24 v10, 2304, v7
    v_add_u32 v20, v9, v10
    s_lshl_b32 s51, s50, 1
    buffer_load_dwordx4 v[24:27], v20, s[40:43], s51 offen
    s_lshl_b32 s48, s52, 7
    s_add_u32 s48, s48, 4608
    v_lshlrev_b32 v16, 4, v5
    v_mul_u32_u24 v9, 13824, v6
    v_add3_u32 v16, v16, v9, s48
    s_mul_i32 s51, s50, 13824
    s_lshl_b32 m0, s50, 7
    s_nop 0
    buffer_load_dwordx4 v16, s[32:35], s51 offen  lds
    s_add_u32 s51, s51, 110592
    s_add_u32 m0, m0, 1024
    s_nop 0
    buffer_load_dwordx4 v16, s[32:35], s51 offen  lds
    s_add_u32 s51, s51, 110592
    s_add_u32 m0, m0, 1024
    s_nop 0
    buffer_load_dwordx4 v16, s[32:35], s51 offen  lds
    s_add_u32 s51, s51, 110592
    s_add_u32 m0, m0, 1024
    s_nop 0
    buffer_load_dwordx4 v16, s[32:35], s51 offen  lds
    s_add_u32 s51, s51, 110592
    s_add_u32 m0, m0, 1024
    s_nop 0
    buffer_load_dwordx4 v16, s[32:35], s51 offen  lds
    s_add_u32 s51, s51, 110592
    s_add_u32 m0, m0, 1024
    s_nop 0
    buffer_load_dwordx4 v16, s[32:35], s51 offen  lds
    s_add_u32 s51, s51, 110592
    s_add_u32 m0, m0, 1024
    s_nop 0
    buffer_load_dwordx4 v16, s[32:35], s51 offen  lds
    s_add_u32 s51, s51, 110592
    s_add_u32 m0, m0, 1024
    s_nop 0
    buffer_load_dwordx4 v16, s[32:35], s51 offen  lds
    s_add_u32 s51, s51, 110592
    s_add_u32 m0, m0, 1024
    s_nop 0
    buffer_load_dwordx4 v16, s[32:35], s51 offen  lds
    s_add_u32 s51, s51, 110592
    s_add_u32 m0, m0, 1024
    s_nop 0
    buffer_load_dwordx4 v16, s[32:35], s51 offen  lds
    s_add_u32 s51, s51, 110592
    s_add_u32 m0, m0, 1024
    s_nop 0
    buffer_load_dwordx4 v16, s[32:35], s51 offen  lds
    s_add_u32 s51, s51, 110592
    s_add_u32 m0, m0, 1024
    s_nop 0
    buffer_load_dwordx4 v16, s[32:35], s51 offen  lds
    s_add_u32 s51, s51, 110592
    s_add_u32 m0, m0, 1024
    s_nop 0
    buffer_load_dwordx4 v16, s[32:35], s51 offen  lds
    s_add_u32 s51, s51, 110592
    s_add_u32 m0, m0, 1024
    s_nop 0
    buffer_load_dwordx4 v16, s[32:35], s51 offen  lds
    s_add_u32 s51, s51, 110592
    s_add_u32 m0, m0, 1024
    s_nop 0
    buffer_load_dwordx4 v16, s[32:35], s51 offen  lds
    s_add_u32 s51, s51, 110592
    s_add_u32 m0, m0, 1024
    s_nop 0
    buffer_load_dwordx4 v16, s[32:35], s51 offen  lds
    s_add_u32 s51, s51, 110592
    s_add_u32 m0, m0, 1024
    s_nop 0
    buffer_load_dwordx4 v16, s[32:35], s51 offen  lds
    s_add_u32 s51, s51, 110592
    s_add_u32 m0, m0, 1024
    s_nop 0
    buffer_load_dwordx4 v16, s[32:35], s51 offen  lds
    s_lshl_b32 s51, s50, 7
    v_add_u32 v17, s51, v3
    v_add_u32 v18, s51, v4
    s_waitcnt vmcnt(18)
    v_lshlrev_b32 v184, 16, v24
    v_and_b32 v185, 0xffff0000, v24
    v_lshlrev_b32 v186, 16, v25
    v_and_b32 v187, 0xffff0000, v25
    v_lshlrev_b32 v188, 16, v26
    v_and_b32 v189, 0xffff0000, v26
    v_lshlrev_b32 v190, 16, v27
    v_and_b32 v191, 0xffff0000, v27
    v_mul_f32 v192, 0xbfb8aa3b, v184
    v_mul_f32 v193, 0xbfb8aa3b, v185
    v_mul_f32 v194, 0xbfb8aa3b, v186
    v_mul_f32 v195, 0xbfb8aa3b, v187
    v_mul_f32 v196, 0xbfb8aa3b, v188
    v_mul_f32 v197, 0xbfb8aa3b, v189
    v_mul_f32 v198, 0xbfb8aa3b, v190
    v_mul_f32 v199, 0xbfb8aa3b, v191
    v_exp_f32 v192, v192
    v_exp_f32 v193, v193
    v_exp_f32 v194, v194
    v_exp_f32 v195, v195
    v_exp_f32 v196, v196
    v_exp_f32 v197, v197
    v_exp_f32 v198, v198
    v_exp_f32 v199, v199
    v_add_f32 v192, 1.0, v192
    v_add_f32 v193, 1.0, v193
    v_add_f32 v194, 1.0, v194
    v_add_f32 v195, 1.0, v195
    v_add_f32 v196, 1.0, v196
    v_add_f32 v197, 1.0, v197
    v_add_f32 v198, 1.0, v198
    v_add_f32 v199, 1.0, v199
    v_rcp_f32 v192, v192
    v_rcp_f32 v193, v193
    v_rcp_f32 v194, v194
    v_rcp_f32 v195, v195
    v_rcp_f32 v196, v196
    v_rcp_f32 v197, v197
    v_rcp_f32 v198, v198
    v_rcp_f32 v199, v199
    v_mul_f32 v184, v184, v192
    v_mul_f32 v185, v185, v193
    v_mul_f32 v186, v186, v194
    v_mul_f32 v187, v187, v195
    v_mul_f32 v188, v188, v196
    v_mul_f32 v189, v189, v197
    v_mul_f32 v190, v190, v198
    v_mul_f32 v191, v191, v199
    v_cvt_pk_bf16_f32 v24, v184, v185
    v_cvt_pk_bf16_f32 v25, v186, v187
    v_cvt_pk_bf16_f32 v26, v188, v189
    v_cvt_pk_bf16_f32 v27, v190, v191
    s_lshl_b32 s51, s50, 1
    s_add_u32 s51, s51, 147456
    v_add_u32 v20, s51, v20
    ds_write_b128 v20, v[24:27]
    v_and_b32 v9, 1, v0
    v_mul_u32_u24 v9, 2304, v9
    v_lshl_add_u32 v9, v7, 4, v9
    v_add_u32 v19, s51, v9
    s_waitcnt lgkmcnt(0)
    s_waitcnt vmcnt(16)
    ds_read_b128 v[160:163], v19 offset:0
    ds_read_b64_tr_b16 v[144:145], v17 offset:0
    ds_read_b64_tr_b16 v[146:147], v17 offset:512
    ds_read_b64_tr_b16 v[148:149], v18 offset:0
    ds_read_b64_tr_b16 v[150:151], v18 offset:512
    s_waitcnt lgkmcnt(2)
    v_mfma_f32_32x32x16_bf16 v[112:127], v[144:147], v[160:163], 0
    s_waitcnt lgkmcnt(0)
    v_mfma_f32_32x32x16_bf16 v[128:143], v[148:151], v[160:163], 0
    s_waitcnt vmcnt(14)
    ds_read_b128 v[164:167], v19 offset:32
    ds_read_b64_tr_b16 v[152:153], v17 offset:2048
    ds_read_b64_tr_b16 v[154:155], v17 offset:2560
    ds_read_b64_tr_b16 v[156:157], v18 offset:2048
    ds_read_b64_tr_b16 v[158:159], v18 offset:2560
    s_waitcnt lgkmcnt(2)
    v_mfma_f32_32x32x16_bf16 v[112:127], v[152:155], v[164:167], v[112:127]
    s_waitcnt lgkmcnt(0)
    v_mfma_f32_32x32x16_bf16 v[128:143], v[156:159], v[164:167], v[128:143]
    s_waitcnt vmcnt(12)
    ds_read_b128 v[160:163], v19 offset:64
    ds_read_b64_tr_b16 v[144:145], v17 offset:4096
    ds_read_b64_tr_b16 v[146:147], v17 offset:4608
    ds_read_b64_tr_b16 v[148:149], v18 offset:4096
    ds_read_b64_tr_b16 v[150:151], v18 offset:4608
    s_waitcnt lgkmcnt(2)
    v_mfma_f32_32x32x16_bf16 v[112:127], v[144:147], v[160:163], v[112:127]
    s_waitcnt lgkmcnt(0)
    v_mfma_f32_32x32x16_bf16 v[128:143], v[148:151], v[160:163], v[128:143]
    s_waitcnt vmcnt(10)
    ds_read_b128 v[164:167], v19 offset:96
    ds_read_b64_tr_b16 v[152:153], v17 offset:6144
    ds_read_b64_tr_b16 v[154:155], v17 offset:6656
    ds_read_b64_tr_b16 v[156:157], v18 offset:6144
    ds_read_b64_tr_b16 v[158:159], v18 offset:6656
    s_waitcnt lgkmcnt(2)
    v_mfma_f32_32x32x16_bf16 v[112:127], v[152:155], v[164:167], v[112:127]
    s_waitcnt lgkmcnt(0)
    v_mfma_f32_32x32x16_bf16 v[128:143], v[156:159], v[164:167], v[128:143]
    s_waitcnt vmcnt(8)
    ds_read_b128 v[160:163], v19 offset:128
    ds_read_b64_tr_b16 v[144:145], v17 offset:8192
    ds_read_b64_tr_b16 v[146:147], v17 offset:8704
    ds_read_b64_tr_b16 v[148:149], v18 offset:8192
    ds_read_b64_tr_b16 v[150:151], v18 offset:8704
    s_waitcnt lgkmcnt(2)
    v_mfma_f32_32x32x16_bf16 v[112:127], v[144:147], v[160:163], v[112:127]
    s_waitcnt lgkmcnt(0)
    v_mfma_f32_32x32x16_bf16 v[128:143], v[148:151], v[160:163], v[128:143]
    s_waitcnt vmcnt(6)
    ds_read_b128 v[164:167], v19 offset:160
    ds_read_b64_tr_b16 v[152:153], v17 offset:10240
    ds_read_b64_tr_b16 v[154:155], v17 offset:10752
    ds_read_b64_tr_b16 v[156:157], v18 offset:10240
    ds_read_b64_tr_b16 v[158:159], v18 offset:10752
    s_waitcnt lgkmcnt(2)
    v_mfma_f32_32x32x16_bf16 v[112:127], v[152:155], v[164:167], v[112:127]
    s_waitcnt lgkmcnt(0)
    v_mfma_f32_32x32x16_bf16 v[128:143], v[156:159], v[164:167], v[128:143]
    s_waitcnt vmcnt(4)
    ds_read_b128 v[160:163], v19 offset:192
    ds_read_b64_tr_b16 v[144:145], v17 offset:12288
    ds_read_b64_tr_b16 v[146:147], v17 offset:12800
    ds_read_b64_tr_b16 v[148:149], v18 offset:12288
    ds_read_b64_tr_b16 v[150:151], v18 offset:12800
    s_waitcnt lgkmcnt(2)
    v_mfma_f32_32x32x16_bf16 v[112:127], v[144:147], v[160:163], v[112:127]
    s_waitcnt lgkmcnt(0)
    v_mfma_f32_32x32x16_bf16 v[128:143], v[148:151], v[160:163], v[128:143]
    s_waitcnt vmcnt(2)
    ds_read_b128 v[164:167], v19 offset:224
    ds_read_b64_tr_b16 v[152:153], v17 offset:14336
    ds_read_b64_tr_b16 v[154:155], v17 offset:14848
    ds_read_b64_tr_b16 v[156:157], v18 offset:14336
    ds_read_b64_tr_b16 v[158:159], v18 offset:14848
    s_waitcnt lgkmcnt(2)
    v_mfma_f32_32x32x16_bf16 v[112:127], v[152:155], v[164:167], v[112:127]
    s_waitcnt lgkmcnt(0)
    v_mfma_f32_32x32x16_bf16 v[128:143], v[156:159], v[164:167], v[128:143]
    s_waitcnt vmcnt(0)
    ds_read_b128 v[160:163], v19 offset:256
    ds_read_b64_tr_b16 v[144:145], v17 offset:16384
    ds_read_b64_tr_b16 v[146:147], v17 offset:16896
    ds_read_b64_tr_b16 v[148:149], v18 offset:16384
    ds_read_b64_tr_b16 v[150:151], v18 offset:16896
    s_waitcnt lgkmcnt(2)
    v_mfma_f32_32x32x16_bf16 v[112:127], v[144:147], v[160:163], v[112:127]
    s_waitcnt lgkmcnt(0)
    v_mfma_f32_32x32x16_bf16 v[128:143], v[148:151], v[160:163], v[128:143]
    v_and_b32 v9, 1, v0
    v_lshlrev_b32 v9, 8, v9
    v_lshl_add_u32 v9, v7, 5, v9
    s_lshl_b32 s51, s3, 9
    s_add_u32 s51, s51, 152064
    v_add_u32 v9, s51, v9
    s_mov_b32 exec_lo, 3
    s_mov_b32 exec_hi, 3
    s_nop 8
    ds_write_b128 v9, v[112:115] offset:0
    ds_write_b128 v9, v[116:119] offset:16
    ds_write_b128 v9, v[120:123] offset:64
    ds_write_b128 v9, v[124:127] offset:80
    ds_write_b128 v9, v[128:131] offset:128
    ds_write_b128 v9, v[132:135] offset:144
    ds_write_b128 v9, v[136:139] offset:192
    ds_write_b128 v9, v[140:143] offset:208
    s_mov_b64 exec, -1
    s_waitcnt lgkmcnt(0)
    s_barrier
    s_lshr_b32 s51, s3, 2
    s_lshl_b32 s51, s51, 8
    s_add_u32 s51, s51, 152064
    v_lshlrev_b32 v9, 2, v0
    v_add_u32 v10, s51, v9
    ds_read_b32 v112, v10 offset:0
    ds_read_b32 v113, v10 offset:512
    ds_read_b32 v114, v10 offset:1024
    ds_read_b32 v115, v10 offset:1536
    ds_read_b32 v116, v10 offset:2048
    ds_read_b32 v117, v10 offset:2560
    ds_read_b32 v118, v10 offset:3072
    ds_read_b32 v119, v10 offset:3584
    s_waitcnt lgkmcnt(0)
    v_add_f32 v112, v112, v113
    v_add_f32 v112, v112, v114
    v_add_f32 v112, v112, v115
    v_add_f32 v112, v112, v116
    v_add_f32 v112, v112, v117
    v_add_f32 v112, v112, v118
    v_add_f32 v112, v112, v119
    v_cvt_pk_bf16_f32 v112, v112, v112
    v_lshlrev_b32 v112, 16, v112
    s_and_b32 s51, s3, 3
    s_cmp_lg_u32 s51, 0
    s_cbranch_scc1 L_gsk_32
    s_lshr_b32 s57, s3, 2
    s_mul_i32 s51, s57, 4608
    s_lshl_b32 s48, s52, 8
    s_add_u32 s51, s51, s48
    s_add_u32 s51, s51, 81920
    buffer_store_dword v112, v9, s[44:47], s51 offen sc1
L_gsk_32:
    s_lshl_b32 s51, s52, 7
    s_add_u32 s51, s51, 16384
    s_waitcnt vmcnt(0)
    s_barrier
    s_cmp_lg_u32 s3, 0
    s_cbranch_scc1 L_fl_33
    v_mov_b32 v12, 0
    s_mov_b64 exec, 1
    buffer_store_dword v13, v12, s[44:47], s51 offen sc1
    s_mov_b64 exec, -1
L_fl_33:
L_o_upd:
    s_add_u32 s6, s6, 25
    s_cmp_ge_u32 s6, 27
    s_cbranch_scc1 L_c_notu
    s_cmp_lg_u32 s2, 0
    s_cbranch_scc1 L_fin
    s_lshl_b32 s51, s3, 6
    v_add_u32 v9, s51, v0
    v_min_u32 v9, 431, v9
    v_lshlrev_b32 v9, 8, v9
    s_mov_b32 s51, 7602176
L_ep_34:
    s_sleep 16
    buffer_load_dword v10, v9, s[44:47], s51 offen sc1
    buffer_load_dword v11, v9, s[44:47], s51 offen offset:128 sc1
    s_waitcnt vmcnt(0)
    v_cmp_ne_u32 vcc, s4, v10
    v_cmp_ne_u32 s[62:63], s4, v11
    s_or_b64 vcc, vcc, s[62:63]
    s_cbranch_vccz L_epd_35
    s_sub_u32 s7, s7, 1
    s_cmp_lg_u32 s7, 0
    s_cbranch_scc1 L_ep_34
L_epd_35:
    s_mov_b32 s51, 77824
    s_waitcnt vmcnt(0)
    s_barrier
    s_cmp_lg_u32 s3, 0
    s_cbranch_scc1 L_fl_36
    v_mov_b32 v12, 0
    s_mov_b64 exec, 1
    buffer_store_dword v13, v12, s[44:47], s51 offen sc1
    s_mov_b64 exec, -1
L_fl_36:
    s_branch L_fin
.p2align 4
L_codeend:
.section .rodata,"a"
.p2align 6
.amdhsa_kernel standalone__dit_adaln_block__diffusion_kernel
  .amdhsa_next_free_vgpr 244
  .amdhsa_next_free_sgpr 102
  .amdhsa_accum_offset 244
  .amdhsa_group_segment_fixed_size 0
  .amdhsa_kernarg_size 64
  .amdhsa_user_sgpr_count 2
  .amdhsa_user_sgpr_kernarg_segment_ptr 1
  .amdhsa_system_sgpr_workgroup_id_x 1
  .amdhsa_float_denorm_mode_32 3
.end_amdhsa_kernel
```
